```python
import torch

def _softmax(x, axis=-1):
    return torch.softmax(x, dim=axis)
def _gelu(x):
    return torch.nn.functional.gelu(x, approximate="tanh")
def _silu(x):
    return torch.nn.functional.silu(x)
def _sigmoid(x):
    return torch.sigmoid(x)
def _layernorm(x, axis=-1, eps=1e-5):
    m = x.mean(dim=axis, keepdim=True)
    v = x.var(dim=axis, keepdim=True, unbiased=False)
    return (x - m) / torch.sqrt(v + eps)
def _scatter_add(tgt, idx, src, axis=0):
    return tgt.clone().index_add_(axis, idx, src)
def _segment_sum(src, seg, n):
    out = torch.zeros((n,) + src.shape[1:], dtype=src.dtype)
    return out.index_add_(0, seg, src)
def _pad(x, pw):
    flat = tuple(v for pair in reversed(pw) for v in pair)
    return torch.nn.functional.pad(x, flat)

kernel_name = 'parallel_sum__gqa_block_cached__mixer_token_mlp__decode'

def setup_inputs():

    _w = (lambda a: (lambda t: t.to(torch.bfloat16) if t.is_floating_point() else t)(torch.as_tensor(a)))
    def _A_setup():
        B, Sq, D = 2, 1, 576
        Hq, Hkv, Sk, Dh = 32, 16, 32768, 128
        assert Hq % Hkv == 0, (Hq, Hkv)
        return {
            "x": _w((lambda *s: torch.randn(*s, dtype=torch.bfloat16) * 0.05)(B, Sq, D)),
            "k_cache": _w((lambda *s: torch.randn(*s, dtype=torch.bfloat16) * 3.2)(B, Hkv, Sk, Dh)),
            "v_cache": _w((lambda *s: torch.randn(*s, dtype=torch.bfloat16) * 0.8)(B, Hkv, Sk, Dh)),
            "wq": _w((lambda *s: torch.randn(*s, dtype=torch.bfloat16) * 3.2)(D, Hq * Dh) * (D ** -0.5)),
            "wo": _w((lambda *s: torch.randn(*s, dtype=torch.bfloat16) * 0.8)(Hq * Dh, D) * ((Hq * Dh) ** -0.5)),
        }
    _A_in = _A_setup()

    def _B_setup():
        B, S, D, F = 2, 1, 576, 4608
        return {
            "x": _w((lambda *s: torch.randn(*s, dtype=torch.bfloat16) * 0.05)(B, S, D)),
            "w1": _w((lambda *s: torch.randn(*s, dtype=torch.bfloat16) * 3.2)(S, F) * (S ** -0.5)),
            "b1": _w((lambda *s: torch.randn(*s, dtype=torch.bfloat16) * 3.2)(F) * 0.02),
            "w2": _w((lambda *s: torch.randn(*s, dtype=torch.bfloat16) * 0.8)(F, S) * (F ** -0.5)),
            "b2": _w((lambda *s: torch.randn(*s, dtype=torch.bfloat16) * 0.8)(S) * 0.02),
        }
    _B_in = _B_setup()

    return {
        "A_x": _A_in["x"],
        "A_k_cache": _A_in["k_cache"],
        "A_v_cache": _A_in["v_cache"],
        "A_wq": _A_in["wq"],
        "A_wo": _A_in["wo"],
        "B_x": _B_in["x"],
        "B_w1": _B_in["w1"],
        "B_b1": _B_in["b1"],
        "B_w2": _B_in["w2"],
        "B_b2": _B_in["b2"],
    }

def reference(A_x, A_k_cache, A_v_cache, A_wq, A_wo, B_x, B_w1, B_b1, B_w2, B_b2):
    def _A_ref(x, k_cache, v_cache, wq, wo):
        B, Sq, D = x.shape
        Hq, Dh = 32, 128
        Hkv = k_cache.shape[1]
        rep = Hq // Hkv
        q = (lambda x, *d: x.permute(*d))((x @ wq).reshape(B, Sq, Hq, Dh), 0, 2, 1, 3)
        k = (lambda x, n, axis: torch.repeat_interleave(x, n, dim=axis))(k_cache, rep, axis=1)
        v = (lambda x, n, axis: torch.repeat_interleave(x, n, dim=axis))(v_cache, rep, axis=1)
        scores = torch.einsum("bhqd,bhkd->bhqk", q, k) * (Dh ** -0.5)
        p = _softmax(scores, axis=-1)
        o = torch.einsum("bhqk,bhkd->bhqd", p, v)
        return (lambda x, *d: x.permute(*d))(o, 0, 2, 1, 3).reshape(B, Sq, Hq * Dh) @ wo

    def _B_ref(x, w1, b1, w2, b2):
        B, S, D = x.shape
        h = _layernorm(x, axis=-1)
        u = torch.einsum("bsd,sf->bdf", h, w1) + b1
        u = _gelu(u)
        y = torch.einsum("bdf,fs->bds", u, w2) + b2
        return (lambda x, *d: x.permute(*d))(y, 0, 2, 1)

    x = A_x
    xn = _layernorm(x, axis=-1)
    return x + _A_ref(xn, A_k_cache, A_v_cache, A_wq, A_wo) + _B_ref(xn, B_w1, B_b1, B_w2, B_b2)
```

```asm
; @launch grid=(256,1,1) block=(512,1,1) lds=146432
.amdgcn_target "amdgcn-amd-amdhsa--gfx950"
.text
.globl parallel_sum__gqa_block_cached__mixer_token_mlp__decode_kernel
.p2align 8
.type parallel_sum__gqa_block_cached__mixer_token_mlp__decode_kernel,@function
parallel_sum__gqa_block_cached__mixer_token_mlp__decode_kernel:
  s_cmp_ge_u32 s2, 256
  s_cbranch_scc1 L_end
  s_load_dwordx16 s[4:19], s[0:1], 0
  s_load_dwordx8 s[20:27], s[0:1], 64
  s_load_dwordx2 s[28:29], s[0:1], 96
  v_lshrrev_b32 v1, 6, v0
  v_and_b32 v2, 15, v0
  v_readfirstlane_b32 s30, v1
  v_and_b32 v1, 63, v0
  v_lshrrev_b32 v3, 4, v1
  s_lshr_b32 s31, s2, 3
  s_and_b32 s32, s2, 7
  s_mov_b32 s50, 975104
  s_mov_b32 s51, 0x20000
  s_cmp_lt_u32 s30, 4
  s_cbranch_scc1 L_helper
  s_sub_u32 s37, s30, 4
  s_setprio 1
  s_lshl_b32 s64, s31, 23
  s_lshl_b32 s38, s32, 20
  s_lshl_b32 s65, s37, 12
  s_add_u32 s38, s38, s65
  s_mov_b32 s39, s38
  s_mov_b32 s42, 8388608
  s_mov_b32 s43, 0x20000
  s_mov_b32 s46, 8388608
  s_mov_b32 s47, 0x20000
  v_lshlrev_b32 v13, 4, v1
  s_sub_u32 s65, s32, s31
  s_and_b32 s59, s65, 3
  s_waitcnt lgkmcnt(0)
  s_add_u32 s44, s8, s64
  s_addc_u32 s45, s9, 0
  s_add_u32 s40, s6, s64
  s_addc_u32 s41, s7, 0
  s_mov_b32 s48, s28
  s_mov_b32 s49, s29
  s_cmp_eq_u32 s59, 0
  s_cbranch_scc0 L_nobx0
  s_barrier
L_nobx0:
  buffer_load_dwordx4 v[64:67], v13, s[44:47], s38 offen offset:0 nt
  buffer_load_dwordx4 v[68:71], v13, s[44:47], s38 offen offset:1024 nt
  buffer_load_dwordx4 v[72:75], v13, s[44:47], s38 offen offset:2048 nt
  buffer_load_dwordx4 v[76:79], v13, s[44:47], s38 offen offset:3072 nt
  s_add_u32 s38, s38, 0x4000
  buffer_load_dwordx4 v[80:83], v13, s[44:47], s38 offen offset:0 nt
  buffer_load_dwordx4 v[84:87], v13, s[44:47], s38 offen offset:1024 nt
  buffer_load_dwordx4 v[88:91], v13, s[44:47], s38 offen offset:2048 nt
  buffer_load_dwordx4 v[92:95], v13, s[44:47], s38 offen offset:3072 nt
  s_add_u32 s38, s38, 0x4000
  buffer_load_dwordx4 v[96:99], v13, s[44:47], s38 offen offset:0 nt
  buffer_load_dwordx4 v[100:103], v13, s[44:47], s38 offen offset:1024 nt
  buffer_load_dwordx4 v[104:107], v13, s[44:47], s38 offen offset:2048 nt
  buffer_load_dwordx4 v[108:111], v13, s[44:47], s38 offen offset:3072 nt
  s_add_u32 s38, s38, 0x4000
  s_cmp_eq_u32 s59, 0
  s_cbranch_scc1 L_nobx
  s_barrier
L_nobx:
  v_mov_b32 v14, 0
  v_mov_b32 v15, 1
  v_lshlrev_b32 v16, 2, v3
  v_xor_b32 v16, v16, v2
  v_lshlrev_b32 v16, 4, v16
  v_lshl_add_u32 v20, v3, 8, v16
  v_xor_b32 v21, 16, v20
  v_xor_b32 v22, 32, v20
  v_xor_b32 v23, 48, v20
  v_and_b32 v16, 3, v2
  v_lshlrev_b32 v16, 10, v16
  v_lshrrev_b32 v17, 2, v2
  v_lshl_add_u32 v16, v17, 8, v16
  v_xor_b32 v17, v3, v2
  v_lshl_add_u32 v4, v17, 4, v16
  v_xor_b32 v5, 64, v4
  v_xor_b32 v6, 128, v4
  v_xor_b32 v7, 192, v4
  s_mul_i32 s55, s37, 24576
  s_add_u32 s55, s55, 14336
  s_add_u32 s57, s55, 24576
  s_mov_b32 s53, s55
  s_mov_b32 s54, s55
  v_lshrrev_b32 v16, 3, v2
  v_lshl_add_u32 v17, v16, 2, v3
  s_mul_i32 s64, s37, 8448
  s_add_u32 s64, s64, 112640
  v_lshl_add_u32 v12, v17, 4, s64
  v_add_u32 v11, 128, v12
  v_lshlrev_b32 v16, 8, v16
  v_lshl_add_u32 v9, v3, 4, v16
  v_mov_b32 v8, 0xff61b1e6
  v_mov_b32 v24, v8
  v_mov_b32 v25, v8
  v_mov_b32 v26, v8
  v_mov_b32 v27, v8
  s_mov_b32 s66, 0x3db504f3
  s_mov_b32 s67, 0x3fb8aa3b
  s_mov_b32 s60, 0x01010101
  s_mov_b32 s61, 0x01010101
  s_cmp_eq_u32 s59, 0
  s_cselect_b32 s52, 52, 55
  s_mov_b32 s71, 0
  s_waitcnt vmcnt(4)
  buffer_load_dwordx4 v[112:115], v13, s[44:47], s38 offen offset:0 nt
  s_waitcnt vmcnt(4)
  buffer_load_dwordx4 v[116:119], v13, s[44:47], s38 offen offset:1024 nt
  s_waitcnt vmcnt(4)
  buffer_load_dwordx4 v[120:123], v13, s[44:47], s38 offen offset:2048 nt
  s_waitcnt vmcnt(4)
  buffer_load_dwordx4 v[124:127], v13, s[44:47], s38 offen offset:3072 nt
  s_add_u32 s38, s38, 0x4000
  s_waitcnt vmcnt(4)
  buffer_load_dwordx4 v[128:131], v13, s[44:47], s38 offen offset:0 nt
  s_waitcnt vmcnt(4)
  buffer_load_dwordx4 v[132:135], v13, s[44:47], s38 offen offset:1024 nt
  s_waitcnt vmcnt(4)
  buffer_load_dwordx4 v[136:139], v13, s[44:47], s38 offen offset:2048 nt
  s_waitcnt vmcnt(4)
  buffer_load_dwordx4 v[140:143], v13, s[44:47], s38 offen offset:3072 nt
  s_add_u32 s38, s38, 0x4000
  s_cmp_eq_u32 s59, 0
  s_cbranch_scc1 L_v0e
  s_waitcnt vmcnt(4)
  buffer_load_dwordx4 v[144:147], v13, s[44:47], s38 offen offset:0 nt
  s_waitcnt vmcnt(4)
  buffer_load_dwordx4 v[148:151], v13, s[44:47], s38 offen offset:1024 nt
  s_waitcnt vmcnt(4)
  buffer_load_dwordx4 v[152:155], v13, s[44:47], s38 offen offset:2048 nt
  s_waitcnt vmcnt(4)
  buffer_load_dwordx4 v[156:159], v13, s[44:47], s38 offen offset:3072 nt
  s_add_u32 s38, s38, 0x4000
  s_waitcnt vmcnt(4)
  buffer_load_dwordx4 v[160:163], v13, s[44:47], s38 offen offset:0 nt
  s_waitcnt vmcnt(4)
  buffer_load_dwordx4 v[164:167], v13, s[44:47], s38 offen offset:1024 nt
  s_waitcnt vmcnt(4)
  buffer_load_dwordx4 v[168:171], v13, s[44:47], s38 offen offset:2048 nt
  s_waitcnt vmcnt(4)
  buffer_load_dwordx4 v[172:175], v13, s[44:47], s38 offen offset:3072 nt
  s_add_u32 s38, s38, 0x4000
  s_waitcnt vmcnt(4)
  buffer_load_dwordx4 v[176:179], v13, s[44:47], s38 offen offset:0 nt
  s_waitcnt vmcnt(4)
  buffer_load_dwordx4 v[180:183], v13, s[44:47], s38 offen offset:1024 nt
  s_waitcnt vmcnt(4)
  buffer_load_dwordx4 v[184:187], v13, s[44:47], s38 offen offset:2048 nt
  s_waitcnt vmcnt(4)
  buffer_load_dwordx4 v[188:191], v13, s[44:47], s38 offen offset:3072 nt
  s_add_u32 s38, s38, 0x4000
L_v0e:
  s_cmp_lg_u32 s59, 0
  s_cbranch_scc1 L_sf_ok
L_sf:
  ds_read_b32 v16, v14 offset:556
  s_waitcnt lgkmcnt(0)
  v_readfirstlane_b32 s64, v16
  s_nop 0
  s_cmp_lt_u32 s64, 4
  s_cbranch_scc1 L_sf
L_sf_ok:
  s_mov_b32 m0, s53
  s_add_u32 s53, s53, 0x1000
  s_waitcnt vmcnt(4)
  buffer_load_dwordx4 v20, s[40:43], s39 offen offset:0 nt lds
  s_waitcnt vmcnt(4)
  buffer_load_dwordx4 v21, s[40:43], s39 offen offset:1024 nt lds
  s_waitcnt vmcnt(4)
  buffer_load_dwordx4 v22, s[40:43], s39 offen offset:2048 nt lds
  s_waitcnt vmcnt(4)
  buffer_load_dwordx4 v23, s[40:43], s39 offen offset:3072 nt lds
  s_add_u32 s39, s39, 0x4000
  s_cmp_eq_u32 s53, s57
  s_cselect_b32 s53, s55, s53
  s_mov_b32 m0, s53
  s_add_u32 s53, s53, 0x1000
  s_waitcnt vmcnt(4)
  buffer_load_dwordx4 v20, s[40:43], s39 offen offset:0 nt lds
  s_waitcnt vmcnt(4)
  buffer_load_dwordx4 v21, s[40:43], s39 offen offset:1024 nt lds
  s_waitcnt vmcnt(4)
  buffer_load_dwordx4 v22, s[40:43], s39 offen offset:2048 nt lds
  s_waitcnt vmcnt(4)
  buffer_load_dwordx4 v23, s[40:43], s39 offen offset:3072 nt lds
  s_add_u32 s39, s39, 0x4000
  s_cmp_eq_u32 s53, s57
  s_cselect_b32 s53, s55, s53
  ds_write_b32 v14, v15 offset:552
  s_mov_b32 m0, s53
  s_add_u32 s53, s53, 0x1000
  s_waitcnt vmcnt(4)
  buffer_load_dwordx4 v20, s[40:43], s39 offen offset:0 nt lds
  s_waitcnt vmcnt(4)
  buffer_load_dwordx4 v21, s[40:43], s39 offen offset:1024 nt lds
  s_waitcnt vmcnt(4)
  buffer_load_dwordx4 v22, s[40:43], s39 offen offset:2048 nt lds
  s_waitcnt vmcnt(4)
  buffer_load_dwordx4 v23, s[40:43], s39 offen offset:3072 nt lds
  s_add_u32 s39, s39, 0x4000
  s_cmp_eq_u32 s53, s57
  s_cselect_b32 s53, s55, s53
  s_mov_b32 m0, s53
  s_add_u32 s53, s53, 0x1000
  s_waitcnt vmcnt(4)
  buffer_load_dwordx4 v20, s[40:43], s39 offen offset:0 nt lds
  s_waitcnt vmcnt(4)
  buffer_load_dwordx4 v21, s[40:43], s39 offen offset:1024 nt lds
  s_waitcnt vmcnt(4)
  buffer_load_dwordx4 v22, s[40:43], s39 offen offset:2048 nt lds
  s_waitcnt vmcnt(4)
  buffer_load_dwordx4 v23, s[40:43], s39 offen offset:3072 nt lds
  s_add_u32 s39, s39, 0x4000
  s_cmp_eq_u32 s53, s57
  s_cselect_b32 s53, s55, s53
  s_mov_b32 m0, s53
  s_add_u32 s53, s53, 0x1000
  s_waitcnt vmcnt(4)
  buffer_load_dwordx4 v20, s[40:43], s39 offen offset:0 nt lds
  s_waitcnt vmcnt(4)
  buffer_load_dwordx4 v21, s[40:43], s39 offen offset:1024 nt lds
  s_waitcnt vmcnt(4)
  buffer_load_dwordx4 v22, s[40:43], s39 offen offset:2048 nt lds
  s_waitcnt vmcnt(4)
  buffer_load_dwordx4 v23, s[40:43], s39 offen offset:3072 nt lds
  s_add_u32 s39, s39, 0x4000
  s_cmp_eq_u32 s53, s57
  s_cselect_b32 s53, s55, s53
L_qw:
  ds_read_b64 v[16:17], v14 offset:512
  ds_read_b128 v[48:51], v9 offset:0
  ds_read_b128 v[52:55], v9 offset:64
  ds_read_b128 v[56:59], v9 offset:128
  ds_read_b128 v[60:63], v9 offset:192
  s_waitcnt lgkmcnt(0)
  v_readfirstlane_b32 s64, v16
  v_readfirstlane_b32 s56, v17
  s_cmp_eq_u32 s64, 0
  s_cbranch_scc1 L_qw
L_kloop:
  s_mov_b32 m0, s53
  s_add_u32 s53, s53, 0x1000
  s_waitcnt vmcnt(4)
  buffer_load_dwordx4 v20, s[40:43], s39 offen offset:0 nt lds
  s_waitcnt vmcnt(4)
  buffer_load_dwordx4 v21, s[40:43], s39 offen offset:1024 nt lds
  v_max3_f32 v8, v8, v24, v25
  v_max3_f32 v8, v8, v26, v27
  s_mov_b64 exec, s[60:61]
  ds_write_b128 v12, v[24:27]
  s_mov_b64 exec, -1
  v_add_u32 v12, 128, v12
  v_add_u32 v16, s54, v4
  v_add_u32 v17, s54, v5
  v_add_u32 v18, s54, v6
  v_add_u32 v19, s54, v7
  ds_read_b128 v[32:35], v16
  ds_read_b128 v[36:39], v17
  ds_read_b128 v[40:43], v18
  ds_read_b128 v[44:47], v19
  s_add_u32 s54, s54, 0x1000
  s_cmp_eq_u32 s54, s57
  s_cselect_b32 s54, s55, s54
  s_waitcnt vmcnt(4)
  buffer_load_dwordx4 v22, s[40:43], s39 offen offset:2048 nt lds
  s_waitcnt vmcnt(4)
  buffer_load_dwordx4 v23, s[40:43], s39 offen offset:3072 nt lds
  s_add_u32 s39, s39, 0x4000
  s_cmp_eq_u32 s53, s57
  s_cselect_b32 s53, s55, s53
  s_waitcnt lgkmcnt(3)
  v_mfma_f32_16x16x32_bf16 v[24:27], v[32:35], v[48:51], 0
  s_waitcnt lgkmcnt(2)
  v_mfma_f32_16x16x32_bf16 v[24:27], v[36:39], v[52:55], v[24:27]
  s_waitcnt lgkmcnt(1)
  v_mfma_f32_16x16x32_bf16 v[24:27], v[40:43], v[56:59], v[24:27]
  s_waitcnt lgkmcnt(0)
  v_mfma_f32_16x16x32_bf16 v[24:27], v[44:47], v[60:63], v[24:27]
  s_sub_u32 s52, s52, 1
  s_cmp_lg_u32 s52, 0
  s_cbranch_scc1 L_kloop
  s_waitcnt vmcnt(4)
  buffer_load_dwordx4 v[192:195], v13, s[44:47], s38 offen offset:0 nt
  s_waitcnt vmcnt(4)
  buffer_load_dwordx4 v[196:199], v13, s[44:47], s38 offen offset:1024 nt
  s_waitcnt vmcnt(18)
  s_nop 2
  v_max3_f32 v8, v8, v24, v25
  v_max3_f32 v8, v8, v26, v27
  s_mov_b64 exec, s[60:61]
  ds_write_b128 v12, v[24:27]
  s_mov_b64 exec, -1
  v_add_u32 v12, 128, v12
  v_add_u32 v16, s54, v4
  v_add_u32 v17, s54, v5
  v_add_u32 v18, s54, v6
  v_add_u32 v19, s54, v7
  ds_read_b128 v[32:35], v16
  ds_read_b128 v[36:39], v17
  ds_read_b128 v[40:43], v18
  ds_read_b128 v[44:47], v19
  s_add_u32 s54, s54, 0x1000
  s_cmp_eq_u32 s54, s57
  s_cselect_b32 s54, s55, s54
  s_waitcnt lgkmcnt(3)
  v_mfma_f32_16x16x32_bf16 v[24:27], v[32:35], v[48:51], 0
  s_waitcnt lgkmcnt(2)
  v_mfma_f32_16x16x32_bf16 v[24:27], v[36:39], v[52:55], v[24:27]
  s_waitcnt lgkmcnt(1)
  v_mfma_f32_16x16x32_bf16 v[24:27], v[40:43], v[56:59], v[24:27]
  s_waitcnt lgkmcnt(0)
  v_mfma_f32_16x16x32_bf16 v[24:27], v[44:47], v[60:63], v[24:27]
  s_waitcnt vmcnt(4)
  buffer_load_dwordx4 v[200:203], v13, s[44:47], s38 offen offset:2048 nt
  s_waitcnt vmcnt(4)
  buffer_load_dwordx4 v[204:207], v13, s[44:47], s38 offen offset:3072 nt
  s_add_u32 s38, s38, 0x4000
  s_waitcnt vmcnt(16)
  s_nop 2
  v_max3_f32 v8, v8, v24, v25
  v_max3_f32 v8, v8, v26, v27
  s_mov_b64 exec, s[60:61]
  ds_write_b128 v12, v[24:27]
  s_mov_b64 exec, -1
  v_add_u32 v12, 128, v12
  v_add_u32 v16, s54, v4
  v_add_u32 v17, s54, v5
  v_add_u32 v18, s54, v6
  v_add_u32 v19, s54, v7
  ds_read_b128 v[32:35], v16
  ds_read_b128 v[36:39], v17
  ds_read_b128 v[40:43], v18
  ds_read_b128 v[44:47], v19
  s_add_u32 s54, s54, 0x1000
  s_cmp_eq_u32 s54, s57
  s_cselect_b32 s54, s55, s54
  s_waitcnt lgkmcnt(3)
  v_mfma_f32_16x16x32_bf16 v[24:27], v[32:35], v[48:51], 0
  s_waitcnt lgkmcnt(2)
  v_mfma_f32_16x16x32_bf16 v[24:27], v[36:39], v[52:55], v[24:27]
  s_waitcnt lgkmcnt(1)
  v_mfma_f32_16x16x32_bf16 v[24:27], v[40:43], v[56:59], v[24:27]
  s_waitcnt lgkmcnt(0)
  v_mfma_f32_16x16x32_bf16 v[24:27], v[44:47], v[60:63], v[24:27]
  s_waitcnt vmcnt(4)
  buffer_load_dwordx4 v[208:211], v13, s[44:47], s38 offen offset:0 nt
  s_waitcnt vmcnt(4)
  buffer_load_dwordx4 v[212:215], v13, s[44:47], s38 offen offset:1024 nt
  s_waitcnt vmcnt(14)
  s_nop 2
  v_max3_f32 v8, v8, v24, v25
  v_max3_f32 v8, v8, v26, v27
  s_mov_b64 exec, s[60:61]
  ds_write_b128 v12, v[24:27]
  s_mov_b64 exec, -1
  v_add_u32 v12, 128, v12
  v_add_u32 v16, s54, v4
  v_add_u32 v17, s54, v5
  v_add_u32 v18, s54, v6
  v_add_u32 v19, s54, v7
  ds_read_b128 v[32:35], v16
  ds_read_b128 v[36:39], v17
  ds_read_b128 v[40:43], v18
  ds_read_b128 v[44:47], v19
  s_add_u32 s54, s54, 0x1000
  s_cmp_eq_u32 s54, s57
  s_cselect_b32 s54, s55, s54
  s_waitcnt lgkmcnt(3)
  v_mfma_f32_16x16x32_bf16 v[24:27], v[32:35], v[48:51], 0
  s_waitcnt lgkmcnt(2)
  v_mfma_f32_16x16x32_bf16 v[24:27], v[36:39], v[52:55], v[24:27]
  s_waitcnt lgkmcnt(1)
  v_mfma_f32_16x16x32_bf16 v[24:27], v[40:43], v[56:59], v[24:27]
  s_waitcnt lgkmcnt(0)
  v_mfma_f32_16x16x32_bf16 v[24:27], v[44:47], v[60:63], v[24:27]
  s_waitcnt vmcnt(4)
  buffer_load_dwordx4 v[216:219], v13, s[44:47], s38 offen offset:2048 nt
  s_nop 1
  s_waitcnt vmcnt(11)
  s_nop 2
  v_max3_f32 v8, v8, v24, v25
  v_max3_f32 v8, v8, v26, v27
  s_mov_b64 exec, s[60:61]
  ds_write_b128 v12, v[24:27]
  s_mov_b64 exec, -1
  v_add_u32 v12, 128, v12
  v_add_u32 v16, s54, v4
  v_add_u32 v17, s54, v5
  v_add_u32 v18, s54, v6
  v_add_u32 v19, s54, v7
  ds_read_b128 v[32:35], v16
  ds_read_b128 v[36:39], v17
  ds_read_b128 v[40:43], v18
  ds_read_b128 v[44:47], v19
  s_add_u32 s54, s54, 0x1000
  s_cmp_eq_u32 s54, s57
  s_cselect_b32 s54, s55, s54
  s_waitcnt lgkmcnt(3)
  v_mfma_f32_16x16x32_bf16 v[24:27], v[32:35], v[48:51], 0
  s_waitcnt lgkmcnt(2)
  v_mfma_f32_16x16x32_bf16 v[24:27], v[36:39], v[52:55], v[24:27]
  s_waitcnt lgkmcnt(1)
  v_mfma_f32_16x16x32_bf16 v[24:27], v[40:43], v[56:59], v[24:27]
  s_waitcnt lgkmcnt(0)
  v_mfma_f32_16x16x32_bf16 v[24:27], v[44:47], v[60:63], v[24:27]
  s_waitcnt vmcnt(4)
  buffer_load_dwordx4 v[220:223], v13, s[44:47], s38 offen offset:3072 nt
  s_add_u32 s38, s38, 0x4000
  s_nop 1
  s_waitcnt vmcnt(8)
  s_nop 2
  v_max3_f32 v8, v8, v24, v25
  v_max3_f32 v8, v8, v26, v27
  s_mov_b64 exec, s[60:61]
  ds_write_b128 v12, v[24:27]
  s_mov_b64 exec, -1
  v_add_u32 v12, 128, v12
  v_add_u32 v16, s54, v4
  v_add_u32 v17, s54, v5
  v_add_u32 v18, s54, v6
  v_add_u32 v19, s54, v7
  ds_read_b128 v[32:35], v16
  ds_read_b128 v[36:39], v17
  ds_read_b128 v[40:43], v18
  ds_read_b128 v[44:47], v19
  s_add_u32 s54, s54, 0x1000
  s_cmp_eq_u32 s54, s57
  s_cselect_b32 s54, s55, s54
  s_waitcnt lgkmcnt(3)
  v_mfma_f32_16x16x32_bf16 v[24:27], v[32:35], v[48:51], 0
  s_waitcnt lgkmcnt(2)
  v_mfma_f32_16x16x32_bf16 v[24:27], v[36:39], v[52:55], v[24:27]
  s_waitcnt lgkmcnt(1)
  v_mfma_f32_16x16x32_bf16 v[24:27], v[40:43], v[56:59], v[24:27]
  s_waitcnt lgkmcnt(0)
  v_mfma_f32_16x16x32_bf16 v[24:27], v[44:47], v[60:63], v[24:27]
  s_waitcnt vmcnt(4)
  buffer_load_dwordx4 v[224:227], v13, s[44:47], s38 offen offset:0 nt
  s_waitcnt vmcnt(4)
  buffer_load_dwordx4 v[228:231], v13, s[44:47], s38 offen offset:1024 nt
  s_nop 3
  v_max3_f32 v8, v8, v24, v25
  v_max3_f32 v8, v8, v26, v27
  s_mov_b64 exec, s[60:61]
  ds_write_b128 v12, v[24:27]
  s_mov_b64 exec, -1
  v_add_u32 v12, 128, v12
  s_cmp_eq_u32 s59, 0
  s_cselect_b32 s64, 5, 8
  s_mov_b32 s52, 11
  s_lshl_b32 s64, s64, 7
  v_add_u32 v12, s64, v11
  ds_read_b128 v[28:31], v12
  ds_read_b128 v[48:51], v11
  v_mov_b32 v7, v8
  s_nop 1
  v_permlane16_swap_b32 v8, v7
  v_max_f32 v8, v8, v7
  v_mov_b32 v7, v8
  s_nop 1
  v_permlane32_swap_b32 v8, v7
  v_max_f32 v8, v8, v7
  v_cvt_pk_bf16_f32 v16, 0, v8
  v_mul_f32 v16, s66, v16
  v_cvt_pk_bf16_f32 v16, 0, v16
  v_mul_f32 v16, s67, v16
  s_waitcnt vmcnt(4)
  buffer_load_dwordx4 v[232:235], v13, s[44:47], s38 offen offset:2048 nt
  v_and_b32 v4, 7, v2
  v_lshrrev_b32 v5, 1, v4
  v_and_b32 v6, 1, v4
  v_mov_b32 v7, 0x0c0c0100
  v_mov_b32 v8, 0x01000c0c
  v_cmp_eq_u32 vcc, 1, v6
  v_mov_b32 v9, 0x0c0c0302
  v_mov_b32 v10, 0x03020c0c
  v_cndmask_b32 v7, v7, v8, vcc
  v_cndmask_b32 v9, v9, v10, vcc
  v_mov_b32 v8, 0x0c0c0c0c
  v_cmp_eq_u32 vcc, 0, v5
  s_nop 1
  v_cndmask_b32 v40, v8, v7, vcc
  v_cndmask_b32 v44, v8, v9, vcc
  v_cmp_eq_u32 vcc, 1, v5
  s_nop 1
  v_cndmask_b32 v41, v8, v7, vcc
  v_cndmask_b32 v45, v8, v9, vcc
  v_cmp_eq_u32 vcc, 2, v5
  s_nop 1
  v_cndmask_b32 v42, v8, v7, vcc
  v_cndmask_b32 v46, v8, v9, vcc
  v_cmp_eq_u32 vcc, 3, v5
  s_nop 1
  v_cndmask_b32 v43, v8, v7, vcc
  v_cndmask_b32 v47, v8, v9, vcc
  v_mov_b32 v4, v16
  v_mov_b32 v20, 0
  v_mov_b32 v21, 0
  v_mov_b32 v22, 0
  v_mov_b32 v23, 0
  v_mov_b32 v5, 0
  s_waitcnt vmcnt(4)
  buffer_load_dwordx4 v[236:239], v13, s[44:47], s38 offen offset:3072 nt
  s_add_u32 s38, s38, 0x4000
  s_waitcnt vmcnt(4)
  buffer_load_dwordx4 v[240:243], v13, s[44:47], s38 offen offset:0 nt
  s_waitcnt lgkmcnt(0)
  v_cvt_pk_bf16_f32 v24, 0, v28
  v_cvt_pk_bf16_f32 v25, 0, v29
  v_cvt_pk_bf16_f32 v26, 0, v30
  v_cvt_pk_bf16_f32 v27, 0, v31
  ds_read_b128 v[28:31], v12 offset:128
  v_mul_f32 v24, s66, v24
  v_mul_f32 v25, s66, v25
  v_mul_f32 v26, s66, v26
  v_mul_f32 v27, s66, v27
  v_cvt_pk_bf16_f32 v24, 0, v24
  v_cvt_pk_bf16_f32 v25, 0, v25
  v_cvt_pk_bf16_f32 v26, 0, v26
  v_cvt_pk_bf16_f32 v27, 0, v27
  v_fma_f32 v24, v24, s67, -v4
  v_fma_f32 v25, v25, s67, -v4
  v_fma_f32 v26, v26, s67, -v4
  v_fma_f32 v27, v27, s67, -v4
  v_exp_f32 v24, v24
  v_exp_f32 v25, v25
  v_exp_f32 v26, v26
  v_exp_f32 v27, v27
  v_cvt_pk_bf16_f32 v16, v24, v25
  v_cvt_pk_bf16_f32 v17, v26, v27
  v_perm_b32 v32, v16, v16, v40
  v_perm_b32 v33, v16, v16, v41
  v_perm_b32 v34, v16, v16, v42
  v_perm_b32 v35, v16, v16, v43
  v_perm_b32 v36, v16, v16, v44
  v_perm_b32 v37, v16, v16, v45
  v_perm_b32 v38, v16, v16, v46
  v_perm_b32 v39, v16, v16, v47
  v_add_f32 v7, v24, v25
  v_add_f32 v8, v26, v27
  s_waitcnt vmcnt(4)
  buffer_load_dwordx4 v[244:247], v13, s[44:47], s38 offen offset:1024 nt
  v_mfma_f32_16x16x32_bf16 v[20:23], v[192:195], v[32:35], v[20:23]
  v_perm_b32 v32, v17, v17, v40
  v_perm_b32 v33, v17, v17, v41
  v_perm_b32 v34, v17, v17, v42
  v_perm_b32 v35, v17, v17, v43
  v_mfma_f32_16x16x32_bf16 v[20:23], v[196:199], v[36:39], v[20:23]
  v_perm_b32 v36, v17, v17, v44
  v_perm_b32 v37, v17, v17, v45
  v_perm_b32 v38, v17, v17, v46
  v_perm_b32 v39, v17, v17, v47
  v_mfma_f32_16x16x32_bf16 v[20:23], v[200:203], v[32:35], v[20:23]
  v_add_f32 v5, v5, v7
  v_add_f32 v5, v5, v8
  v_mfma_f32_16x16x32_bf16 v[20:23], v[204:207], v[36:39], v[20:23]
  s_waitcnt vmcnt(4)
  buffer_load_dwordx4 v[248:251], v13, s[44:47], s38 offen offset:2048 nt
  s_waitcnt lgkmcnt(0)
  v_cvt_pk_bf16_f32 v24, 0, v48
  v_cvt_pk_bf16_f32 v25, 0, v49
  v_cvt_pk_bf16_f32 v26, 0, v50
  v_cvt_pk_bf16_f32 v27, 0, v51
  ds_read_b128 v[48:51], v11 offset:128
  v_mul_f32 v24, s66, v24
  v_mul_f32 v25, s66, v25
  v_mul_f32 v26, s66, v26
  v_mul_f32 v27, s66, v27
  v_cvt_pk_bf16_f32 v24, 0, v24
  v_cvt_pk_bf16_f32 v25, 0, v25
  v_cvt_pk_bf16_f32 v26, 0, v26
  v_cvt_pk_bf16_f32 v27, 0, v27
  v_fma_f32 v24, v24, s67, -v4
  v_fma_f32 v25, v25, s67, -v4
  v_fma_f32 v26, v26, s67, -v4
  v_fma_f32 v27, v27, s67, -v4
  v_exp_f32 v24, v24
  v_exp_f32 v25, v25
  v_exp_f32 v26, v26
  v_exp_f32 v27, v27
  v_cvt_pk_bf16_f32 v16, v24, v25
  v_cvt_pk_bf16_f32 v17, v26, v27
  v_perm_b32 v32, v16, v16, v40
  v_perm_b32 v33, v16, v16, v41
  v_perm_b32 v34, v16, v16, v42
  v_perm_b32 v35, v16, v16, v43
  v_perm_b32 v36, v16, v16, v44
  v_perm_b32 v37, v16, v16, v45
  v_perm_b32 v38, v16, v16, v46
  v_perm_b32 v39, v16, v16, v47
  v_add_f32 v7, v24, v25
  v_add_f32 v8, v26, v27
  s_waitcnt vmcnt(4)
  buffer_load_dwordx4 v[252:255], v13, s[44:47], s38 offen offset:3072 nt
  v_mfma_f32_16x16x32_bf16 v[20:23], v[64:67], v[32:35], v[20:23]
  v_perm_b32 v32, v17, v17, v40
  v_perm_b32 v33, v17, v17, v41
  v_perm_b32 v34, v17, v17, v42
  v_perm_b32 v35, v17, v17, v43
  v_mfma_f32_16x16x32_bf16 v[20:23], v[68:71], v[36:39], v[20:23]
  v_perm_b32 v36, v17, v17, v44
  v_perm_b32 v37, v17, v17, v45
  v_perm_b32 v38, v17, v17, v46
  v_perm_b32 v39, v17, v17, v47
  v_mfma_f32_16x16x32_bf16 v[20:23], v[72:75], v[32:35], v[20:23]
  v_add_f32 v5, v5, v7
  v_add_f32 v5, v5, v8
  v_mfma_f32_16x16x32_bf16 v[20:23], v[76:79], v[36:39], v[20:23]
L_he0:
  s_add_u32 s38, s38, 0x4000
  s_waitcnt vmcnt(4)
  buffer_load_dwordx4 v[192:195], v13, s[44:47], s38 offen offset:0 nt
  s_waitcnt lgkmcnt(0)
  v_cvt_pk_bf16_f32 v24, 0, v28
  v_cvt_pk_bf16_f32 v25, 0, v29
  v_cvt_pk_bf16_f32 v26, 0, v30
  v_cvt_pk_bf16_f32 v27, 0, v31
  ds_read_b128 v[28:31], v12 offset:256
  v_mul_f32 v24, s66, v24
  v_mul_f32 v25, s66, v25
  v_mul_f32 v26, s66, v26
  v_mul_f32 v27, s66, v27
  v_cvt_pk_bf16_f32 v24, 0, v24
  v_cvt_pk_bf16_f32 v25, 0, v25
  v_cvt_pk_bf16_f32 v26, 0, v26
  v_cvt_pk_bf16_f32 v27, 0, v27
  v_fma_f32 v24, v24, s67, -v4
  v_fma_f32 v25, v25, s67, -v4
  v_fma_f32 v26, v26, s67, -v4
  v_fma_f32 v27, v27, s67, -v4
  v_exp_f32 v24, v24
  v_exp_f32 v25, v25
  v_exp_f32 v26, v26
  v_exp_f32 v27, v27
  v_cvt_pk_bf16_f32 v16, v24, v25
  v_cvt_pk_bf16_f32 v17, v26, v27
  v_perm_b32 v32, v16, v16, v40
  v_perm_b32 v33, v16, v16, v41
  v_perm_b32 v34, v16, v16, v42
  v_perm_b32 v35, v16, v16, v43
  v_perm_b32 v36, v16, v16, v44
  v_perm_b32 v37, v16, v16, v45
  v_perm_b32 v38, v16, v16, v46
  v_perm_b32 v39, v16, v16, v47
  v_add_f32 v7, v24, v25
  v_add_f32 v8, v26, v27
  s_waitcnt vmcnt(4)
  buffer_load_dwordx4 v[196:199], v13, s[44:47], s38 offen offset:1024 nt
  v_mfma_f32_16x16x32_bf16 v[20:23], v[208:211], v[32:35], v[20:23]
  v_perm_b32 v32, v17, v17, v40
  v_perm_b32 v33, v17, v17, v41
  v_perm_b32 v34, v17, v17, v42
  v_perm_b32 v35, v17, v17, v43
  v_mfma_f32_16x16x32_bf16 v[20:23], v[212:215], v[36:39], v[20:23]
  v_perm_b32 v36, v17, v17, v44
  v_perm_b32 v37, v17, v17, v45
  v_perm_b32 v38, v17, v17, v46
  v_perm_b32 v39, v17, v17, v47
  v_mfma_f32_16x16x32_bf16 v[20:23], v[216:219], v[32:35], v[20:23]
  v_add_f32 v5, v5, v7
  v_add_f32 v5, v5, v8
  v_mfma_f32_16x16x32_bf16 v[20:23], v[220:223], v[36:39], v[20:23]
  s_waitcnt vmcnt(4)
  buffer_load_dwordx4 v[200:203], v13, s[44:47], s38 offen offset:2048 nt
  s_waitcnt lgkmcnt(0)
  v_cvt_pk_bf16_f32 v24, 0, v48
  v_cvt_pk_bf16_f32 v25, 0, v49
  v_cvt_pk_bf16_f32 v26, 0, v50
  v_cvt_pk_bf16_f32 v27, 0, v51
  ds_read_b128 v[48:51], v11 offset:256
  v_mul_f32 v24, s66, v24
  v_mul_f32 v25, s66, v25
  v_mul_f32 v26, s66, v26
  v_mul_f32 v27, s66, v27
  v_cvt_pk_bf16_f32 v24, 0, v24
  v_cvt_pk_bf16_f32 v25, 0, v25
  v_cvt_pk_bf16_f32 v26, 0, v26
  v_cvt_pk_bf16_f32 v27, 0, v27
  v_fma_f32 v24, v24, s67, -v4
  v_fma_f32 v25, v25, s67, -v4
  v_fma_f32 v26, v26, s67, -v4
  v_fma_f32 v27, v27, s67, -v4
  v_exp_f32 v24, v24
  v_exp_f32 v25, v25
  v_exp_f32 v26, v26
  v_exp_f32 v27, v27
  v_cvt_pk_bf16_f32 v16, v24, v25
  v_cvt_pk_bf16_f32 v17, v26, v27
  v_perm_b32 v32, v16, v16, v40
  v_perm_b32 v33, v16, v16, v41
  v_perm_b32 v34, v16, v16, v42
  v_perm_b32 v35, v16, v16, v43
  v_perm_b32 v36, v16, v16, v44
  v_perm_b32 v37, v16, v16, v45
  v_perm_b32 v38, v16, v16, v46
  v_perm_b32 v39, v16, v16, v47
  v_add_f32 v7, v24, v25
  v_add_f32 v8, v26, v27
  s_waitcnt vmcnt(4)
  buffer_load_dwordx4 v[204:207], v13, s[44:47], s38 offen offset:3072 nt
  v_mfma_f32_16x16x32_bf16 v[20:23], v[80:83], v[32:35], v[20:23]
  v_perm_b32 v32, v17, v17, v40
  v_perm_b32 v33, v17, v17, v41
  v_perm_b32 v34, v17, v17, v42
  v_perm_b32 v35, v17, v17, v43
  v_mfma_f32_16x16x32_bf16 v[20:23], v[84:87], v[36:39], v[20:23]
  v_perm_b32 v36, v17, v17, v44
  v_perm_b32 v37, v17, v17, v45
  v_perm_b32 v38, v17, v17, v46
  v_perm_b32 v39, v17, v17, v47
  v_mfma_f32_16x16x32_bf16 v[20:23], v[88:91], v[32:35], v[20:23]
  v_add_f32 v5, v5, v7
  v_add_f32 v5, v5, v8
  v_mfma_f32_16x16x32_bf16 v[20:23], v[92:95], v[36:39], v[20:23]
L_he1:
  s_add_u32 s38, s38, 0x4000
  s_waitcnt vmcnt(4)
  buffer_load_dwordx4 v[208:211], v13, s[44:47], s38 offen offset:0 nt
  s_waitcnt lgkmcnt(0)
  v_cvt_pk_bf16_f32 v24, 0, v28
  v_cvt_pk_bf16_f32 v25, 0, v29
  v_cvt_pk_bf16_f32 v26, 0, v30
  v_cvt_pk_bf16_f32 v27, 0, v31
  ds_read_b128 v[28:31], v12 offset:384
  v_mul_f32 v24, s66, v24
  v_mul_f32 v25, s66, v25
  v_mul_f32 v26, s66, v26
  v_mul_f32 v27, s66, v27
  v_cvt_pk_bf16_f32 v24, 0, v24
  v_cvt_pk_bf16_f32 v25, 0, v25
  v_cvt_pk_bf16_f32 v26, 0, v26
  v_cvt_pk_bf16_f32 v27, 0, v27
  v_fma_f32 v24, v24, s67, -v4
  v_fma_f32 v25, v25, s67, -v4
  v_fma_f32 v26, v26, s67, -v4
  v_fma_f32 v27, v27, s67, -v4
  v_exp_f32 v24, v24
  v_exp_f32 v25, v25
  v_exp_f32 v26, v26
  v_exp_f32 v27, v27
  v_cvt_pk_bf16_f32 v16, v24, v25
  v_cvt_pk_bf16_f32 v17, v26, v27
  v_perm_b32 v32, v16, v16, v40
  v_perm_b32 v33, v16, v16, v41
  v_perm_b32 v34, v16, v16, v42
  v_perm_b32 v35, v16, v16, v43
  v_perm_b32 v36, v16, v16, v44
  v_perm_b32 v37, v16, v16, v45
  v_perm_b32 v38, v16, v16, v46
  v_perm_b32 v39, v16, v16, v47
  v_add_f32 v7, v24, v25
  v_add_f32 v8, v26, v27
  s_waitcnt vmcnt(4)
  buffer_load_dwordx4 v[212:215], v13, s[44:47], s38 offen offset:1024 nt
  v_mfma_f32_16x16x32_bf16 v[20:23], v[224:227], v[32:35], v[20:23]
  v_perm_b32 v32, v17, v17, v40
  v_perm_b32 v33, v17, v17, v41
  v_perm_b32 v34, v17, v17, v42
  v_perm_b32 v35, v17, v17, v43
  v_mfma_f32_16x16x32_bf16 v[20:23], v[228:231], v[36:39], v[20:23]
  v_perm_b32 v36, v17, v17, v44
  v_perm_b32 v37, v17, v17, v45
  v_perm_b32 v38, v17, v17, v46
  v_perm_b32 v39, v17, v17, v47
  v_mfma_f32_16x16x32_bf16 v[20:23], v[232:235], v[32:35], v[20:23]
  v_add_f32 v5, v5, v7
  v_add_f32 v5, v5, v8
  v_mfma_f32_16x16x32_bf16 v[20:23], v[236:239], v[36:39], v[20:23]
  s_waitcnt vmcnt(4)
  buffer_load_dwordx4 v[216:219], v13, s[44:47], s38 offen offset:2048 nt
  s_waitcnt lgkmcnt(0)
  v_cvt_pk_bf16_f32 v24, 0, v48
  v_cvt_pk_bf16_f32 v25, 0, v49
  v_cvt_pk_bf16_f32 v26, 0, v50
  v_cvt_pk_bf16_f32 v27, 0, v51
  ds_read_b128 v[48:51], v11 offset:384
  v_mul_f32 v24, s66, v24
  v_mul_f32 v25, s66, v25
  v_mul_f32 v26, s66, v26
  v_mul_f32 v27, s66, v27
  v_cvt_pk_bf16_f32 v24, 0, v24
  v_cvt_pk_bf16_f32 v25, 0, v25
  v_cvt_pk_bf16_f32 v26, 0, v26
  v_cvt_pk_bf16_f32 v27, 0, v27
  v_fma_f32 v24, v24, s67, -v4
  v_fma_f32 v25, v25, s67, -v4
  v_fma_f32 v26, v26, s67, -v4
  v_fma_f32 v27, v27, s67, -v4
  v_exp_f32 v24, v24
  v_exp_f32 v25, v25
  v_exp_f32 v26, v26
  v_exp_f32 v27, v27
  v_cvt_pk_bf16_f32 v16, v24, v25
  v_cvt_pk_bf16_f32 v17, v26, v27
  v_perm_b32 v32, v16, v16, v40
  v_perm_b32 v33, v16, v16, v41
  v_perm_b32 v34, v16, v16, v42
  v_perm_b32 v35, v16, v16, v43
  v_perm_b32 v36, v16, v16, v44
  v_perm_b32 v37, v16, v16, v45
  v_perm_b32 v38, v16, v16, v46
  v_perm_b32 v39, v16, v16, v47
  v_add_f32 v7, v24, v25
  v_add_f32 v8, v26, v27
  s_waitcnt vmcnt(4)
  buffer_load_dwordx4 v[220:223], v13, s[44:47], s38 offen offset:3072 nt
  v_mfma_f32_16x16x32_bf16 v[20:23], v[96:99], v[32:35], v[20:23]
  v_perm_b32 v32, v17, v17, v40
  v_perm_b32 v33, v17, v17, v41
  v_perm_b32 v34, v17, v17, v42
  v_perm_b32 v35, v17, v17, v43
  v_mfma_f32_16x16x32_bf16 v[20:23], v[100:103], v[36:39], v[20:23]
  v_perm_b32 v36, v17, v17, v44
  v_perm_b32 v37, v17, v17, v45
  v_perm_b32 v38, v17, v17, v46
  v_perm_b32 v39, v17, v17, v47
  v_mfma_f32_16x16x32_bf16 v[20:23], v[104:107], v[32:35], v[20:23]
  v_add_f32 v5, v5, v7
  v_add_f32 v5, v5, v8
  v_mfma_f32_16x16x32_bf16 v[20:23], v[108:111], v[36:39], v[20:23]
L_he2:
  s_add_u32 s38, s38, 0x4000
  s_waitcnt vmcnt(4)
  buffer_load_dwordx4 v[224:227], v13, s[44:47], s38 offen offset:0 nt
  s_waitcnt lgkmcnt(0)
  v_cvt_pk_bf16_f32 v24, 0, v28
  v_cvt_pk_bf16_f32 v25, 0, v29
  v_cvt_pk_bf16_f32 v26, 0, v30
  v_cvt_pk_bf16_f32 v27, 0, v31
  ds_read_b128 v[28:31], v12 offset:512
  v_mul_f32 v24, s66, v24
  v_mul_f32 v25, s66, v25
  v_mul_f32 v26, s66, v26
  v_mul_f32 v27, s66, v27
  v_cvt_pk_bf16_f32 v24, 0, v24
  v_cvt_pk_bf16_f32 v25, 0, v25
  v_cvt_pk_bf16_f32 v26, 0, v26
  v_cvt_pk_bf16_f32 v27, 0, v27
  v_fma_f32 v24, v24, s67, -v4
  v_fma_f32 v25, v25, s67, -v4
  v_fma_f32 v26, v26, s67, -v4
  v_fma_f32 v27, v27, s67, -v4
  v_exp_f32 v24, v24
  v_exp_f32 v25, v25
  v_exp_f32 v26, v26
  v_exp_f32 v27, v27
  v_cvt_pk_bf16_f32 v16, v24, v25
  v_cvt_pk_bf16_f32 v17, v26, v27
  v_perm_b32 v32, v16, v16, v40
  v_perm_b32 v33, v16, v16, v41
  v_perm_b32 v34, v16, v16, v42
  v_perm_b32 v35, v16, v16, v43
  v_perm_b32 v36, v16, v16, v44
  v_perm_b32 v37, v16, v16, v45
  v_perm_b32 v38, v16, v16, v46
  v_perm_b32 v39, v16, v16, v47
  v_add_f32 v7, v24, v25
  v_add_f32 v8, v26, v27
  s_waitcnt vmcnt(4)
  buffer_load_dwordx4 v[228:231], v13, s[44:47], s38 offen offset:1024 nt
  v_mfma_f32_16x16x32_bf16 v[20:23], v[240:243], v[32:35], v[20:23]
  v_perm_b32 v32, v17, v17, v40
  v_perm_b32 v33, v17, v17, v41
  v_perm_b32 v34, v17, v17, v42
  v_perm_b32 v35, v17, v17, v43
  v_mfma_f32_16x16x32_bf16 v[20:23], v[244:247], v[36:39], v[20:23]
  v_perm_b32 v36, v17, v17, v44
  v_perm_b32 v37, v17, v17, v45
  v_perm_b32 v38, v17, v17, v46
  v_perm_b32 v39, v17, v17, v47
  v_mfma_f32_16x16x32_bf16 v[20:23], v[248:251], v[32:35], v[20:23]
  v_add_f32 v5, v5, v7
  v_add_f32 v5, v5, v8
  v_mfma_f32_16x16x32_bf16 v[20:23], v[252:255], v[36:39], v[20:23]
  s_waitcnt vmcnt(4)
  buffer_load_dwordx4 v[232:235], v13, s[44:47], s38 offen offset:2048 nt
  s_waitcnt lgkmcnt(0)
  v_cvt_pk_bf16_f32 v24, 0, v48
  v_cvt_pk_bf16_f32 v25, 0, v49
  v_cvt_pk_bf16_f32 v26, 0, v50
  v_cvt_pk_bf16_f32 v27, 0, v51
  ds_read_b128 v[48:51], v11 offset:512
  v_mul_f32 v24, s66, v24
  v_mul_f32 v25, s66, v25
  v_mul_f32 v26, s66, v26
  v_mul_f32 v27, s66, v27
  v_cvt_pk_bf16_f32 v24, 0, v24
  v_cvt_pk_bf16_f32 v25, 0, v25
  v_cvt_pk_bf16_f32 v26, 0, v26
  v_cvt_pk_bf16_f32 v27, 0, v27
  v_fma_f32 v24, v24, s67, -v4
  v_fma_f32 v25, v25, s67, -v4
  v_fma_f32 v26, v26, s67, -v4
  v_fma_f32 v27, v27, s67, -v4
  v_exp_f32 v24, v24
  v_exp_f32 v25, v25
  v_exp_f32 v26, v26
  v_exp_f32 v27, v27
  v_cvt_pk_bf16_f32 v16, v24, v25
  v_cvt_pk_bf16_f32 v17, v26, v27
  v_perm_b32 v32, v16, v16, v40
  v_perm_b32 v33, v16, v16, v41
  v_perm_b32 v34, v16, v16, v42
  v_perm_b32 v35, v16, v16, v43
  v_perm_b32 v36, v16, v16, v44
  v_perm_b32 v37, v16, v16, v45
  v_perm_b32 v38, v16, v16, v46
  v_perm_b32 v39, v16, v16, v47
  v_add_f32 v7, v24, v25
  v_add_f32 v8, v26, v27
  s_waitcnt vmcnt(4)
  buffer_load_dwordx4 v[236:239], v13, s[44:47], s38 offen offset:3072 nt
  v_mfma_f32_16x16x32_bf16 v[20:23], v[112:115], v[32:35], v[20:23]
  v_perm_b32 v32, v17, v17, v40
  v_perm_b32 v33, v17, v17, v41
  v_perm_b32 v34, v17, v17, v42
  v_perm_b32 v35, v17, v17, v43
  v_mfma_f32_16x16x32_bf16 v[20:23], v[116:119], v[36:39], v[20:23]
  v_perm_b32 v36, v17, v17, v44
  v_perm_b32 v37, v17, v17, v45
  v_perm_b32 v38, v17, v17, v46
  v_perm_b32 v39, v17, v17, v47
  v_mfma_f32_16x16x32_bf16 v[20:23], v[120:123], v[32:35], v[20:23]
  v_add_f32 v5, v5, v7
  v_add_f32 v5, v5, v8
  v_mfma_f32_16x16x32_bf16 v[20:23], v[124:127], v[36:39], v[20:23]
L_he3:
  s_add_u32 s38, s38, 0x4000
  s_waitcnt vmcnt(4)
  buffer_load_dwordx4 v[240:243], v13, s[44:47], s38 offen offset:0 nt
  s_waitcnt lgkmcnt(0)
  v_cvt_pk_bf16_f32 v24, 0, v28
  v_cvt_pk_bf16_f32 v25, 0, v29
  v_cvt_pk_bf16_f32 v26, 0, v30
  v_cvt_pk_bf16_f32 v27, 0, v31
  ds_read_b128 v[28:31], v12 offset:640
  v_mul_f32 v24, s66, v24
  v_mul_f32 v25, s66, v25
  v_mul_f32 v26, s66, v26
  v_mul_f32 v27, s66, v27
  v_cvt_pk_bf16_f32 v24, 0, v24
  v_cvt_pk_bf16_f32 v25, 0, v25
  v_cvt_pk_bf16_f32 v26, 0, v26
  v_cvt_pk_bf16_f32 v27, 0, v27
  v_fma_f32 v24, v24, s67, -v4
  v_fma_f32 v25, v25, s67, -v4
  v_fma_f32 v26, v26, s67, -v4
  v_fma_f32 v27, v27, s67, -v4
  v_exp_f32 v24, v24
  v_exp_f32 v25, v25
  v_exp_f32 v26, v26
  v_exp_f32 v27, v27
  v_cvt_pk_bf16_f32 v16, v24, v25
  v_cvt_pk_bf16_f32 v17, v26, v27
  v_perm_b32 v32, v16, v16, v40
  v_perm_b32 v33, v16, v16, v41
  v_perm_b32 v34, v16, v16, v42
  v_perm_b32 v35, v16, v16, v43
  v_perm_b32 v36, v16, v16, v44
  v_perm_b32 v37, v16, v16, v45
  v_perm_b32 v38, v16, v16, v46
  v_perm_b32 v39, v16, v16, v47
  v_add_f32 v7, v24, v25
  v_add_f32 v8, v26, v27
  s_waitcnt vmcnt(4)
  buffer_load_dwordx4 v[244:247], v13, s[44:47], s38 offen offset:1024 nt
  v_mfma_f32_16x16x32_bf16 v[20:23], v[192:195], v[32:35], v[20:23]
  v_perm_b32 v32, v17, v17, v40
  v_perm_b32 v33, v17, v17, v41
  v_perm_b32 v34, v17, v17, v42
  v_perm_b32 v35, v17, v17, v43
  v_mfma_f32_16x16x32_bf16 v[20:23], v[196:199], v[36:39], v[20:23]
  v_perm_b32 v36, v17, v17, v44
  v_perm_b32 v37, v17, v17, v45
  v_perm_b32 v38, v17, v17, v46
  v_perm_b32 v39, v17, v17, v47
  v_mfma_f32_16x16x32_bf16 v[20:23], v[200:203], v[32:35], v[20:23]
  v_add_f32 v5, v5, v7
  v_add_f32 v5, v5, v8
  v_mfma_f32_16x16x32_bf16 v[20:23], v[204:207], v[36:39], v[20:23]
  s_waitcnt vmcnt(4)
  buffer_load_dwordx4 v[248:251], v13, s[44:47], s38 offen offset:2048 nt
  s_waitcnt lgkmcnt(0)
  v_cvt_pk_bf16_f32 v24, 0, v48
  v_cvt_pk_bf16_f32 v25, 0, v49
  v_cvt_pk_bf16_f32 v26, 0, v50
  v_cvt_pk_bf16_f32 v27, 0, v51
  ds_read_b128 v[48:51], v11 offset:640
  v_mul_f32 v24, s66, v24
  v_mul_f32 v25, s66, v25
  v_mul_f32 v26, s66, v26
  v_mul_f32 v27, s66, v27
  v_cvt_pk_bf16_f32 v24, 0, v24
  v_cvt_pk_bf16_f32 v25, 0, v25
  v_cvt_pk_bf16_f32 v26, 0, v26
  v_cvt_pk_bf16_f32 v27, 0, v27
  v_fma_f32 v24, v24, s67, -v4
  v_fma_f32 v25, v25, s67, -v4
  v_fma_f32 v26, v26, s67, -v4
  v_fma_f32 v27, v27, s67, -v4
  v_exp_f32 v24, v24
  v_exp_f32 v25, v25
  v_exp_f32 v26, v26
  v_exp_f32 v27, v27
  v_cvt_pk_bf16_f32 v16, v24, v25
  v_cvt_pk_bf16_f32 v17, v26, v27
  v_perm_b32 v32, v16, v16, v40
  v_perm_b32 v33, v16, v16, v41
  v_perm_b32 v34, v16, v16, v42
  v_perm_b32 v35, v16, v16, v43
  v_perm_b32 v36, v16, v16, v44
  v_perm_b32 v37, v16, v16, v45
  v_perm_b32 v38, v16, v16, v46
  v_perm_b32 v39, v16, v16, v47
  v_add_f32 v7, v24, v25
  v_add_f32 v8, v26, v27
  s_waitcnt vmcnt(4)
  buffer_load_dwordx4 v[252:255], v13, s[44:47], s38 offen offset:3072 nt
  v_mfma_f32_16x16x32_bf16 v[20:23], v[128:131], v[32:35], v[20:23]
  v_perm_b32 v32, v17, v17, v40
  v_perm_b32 v33, v17, v17, v41
  v_perm_b32 v34, v17, v17, v42
  v_perm_b32 v35, v17, v17, v43
  v_mfma_f32_16x16x32_bf16 v[20:23], v[132:135], v[36:39], v[20:23]
  v_perm_b32 v36, v17, v17, v44
  v_perm_b32 v37, v17, v17, v45
  v_perm_b32 v38, v17, v17, v46
  v_perm_b32 v39, v17, v17, v47
  v_mfma_f32_16x16x32_bf16 v[20:23], v[136:139], v[32:35], v[20:23]
  v_add_f32 v5, v5, v7
  v_add_f32 v5, v5, v8
  v_mfma_f32_16x16x32_bf16 v[20:23], v[140:143], v[36:39], v[20:23]
L_he4:
  s_add_u32 s38, s38, 0x4000
  s_waitcnt vmcnt(4)
  buffer_load_dwordx4 v[192:195], v13, s[44:47], s38 offen offset:0 nt
  s_waitcnt lgkmcnt(0)
  v_cvt_pk_bf16_f32 v24, 0, v28
  v_cvt_pk_bf16_f32 v25, 0, v29
  v_cvt_pk_bf16_f32 v26, 0, v30
  v_cvt_pk_bf16_f32 v27, 0, v31
  ds_read_b128 v[28:31], v12 offset:768
  v_mul_f32 v24, s66, v24
  v_mul_f32 v25, s66, v25
  v_mul_f32 v26, s66, v26
  v_mul_f32 v27, s66, v27
  v_cvt_pk_bf16_f32 v24, 0, v24
  v_cvt_pk_bf16_f32 v25, 0, v25
  v_cvt_pk_bf16_f32 v26, 0, v26
  v_cvt_pk_bf16_f32 v27, 0, v27
  v_fma_f32 v24, v24, s67, -v4
  v_fma_f32 v25, v25, s67, -v4
  v_fma_f32 v26, v26, s67, -v4
  v_fma_f32 v27, v27, s67, -v4
  v_exp_f32 v24, v24
  v_exp_f32 v25, v25
  v_exp_f32 v26, v26
  v_exp_f32 v27, v27
  v_cvt_pk_bf16_f32 v16, v24, v25
  v_cvt_pk_bf16_f32 v17, v26, v27
  v_perm_b32 v32, v16, v16, v40
  v_perm_b32 v33, v16, v16, v41
  v_perm_b32 v34, v16, v16, v42
  v_perm_b32 v35, v16, v16, v43
  v_perm_b32 v36, v16, v16, v44
  v_perm_b32 v37, v16, v16, v45
  v_perm_b32 v38, v16, v16, v46
  v_perm_b32 v39, v16, v16, v47
  v_add_f32 v7, v24, v25
  v_add_f32 v8, v26, v27
  s_waitcnt vmcnt(4)
  buffer_load_dwordx4 v[196:199], v13, s[44:47], s38 offen offset:1024 nt
  v_mfma_f32_16x16x32_bf16 v[20:23], v[208:211], v[32:35], v[20:23]
  v_perm_b32 v32, v17, v17, v40
  v_perm_b32 v33, v17, v17, v41
  v_perm_b32 v34, v17, v17, v42
  v_perm_b32 v35, v17, v17, v43
  v_mfma_f32_16x16x32_bf16 v[20:23], v[212:215], v[36:39], v[20:23]
  v_perm_b32 v36, v17, v17, v44
  v_perm_b32 v37, v17, v17, v45
  v_perm_b32 v38, v17, v17, v46
  v_perm_b32 v39, v17, v17, v47
  v_mfma_f32_16x16x32_bf16 v[20:23], v[216:219], v[32:35], v[20:23]
  v_add_f32 v5, v5, v7
  v_add_f32 v5, v5, v8
  v_mfma_f32_16x16x32_bf16 v[20:23], v[220:223], v[36:39], v[20:23]
  s_cmp_eq_u32 s59, 0
  s_cbranch_scc0 L_hb5
  s_waitcnt vmcnt(4)
  buffer_load_dwordx4 v[200:203], v13, s[44:47], s38 offen offset:2048 nt
  s_waitcnt vmcnt(4)
  buffer_load_dwordx4 v[204:207], v13, s[44:47], s38 offen offset:3072 nt
  s_branch L_he5
L_hb5:
  s_waitcnt vmcnt(4)
  buffer_load_dwordx4 v[200:203], v13, s[44:47], s38 offen offset:2048 nt
  s_waitcnt lgkmcnt(0)
  v_cvt_pk_bf16_f32 v24, 0, v48
  v_cvt_pk_bf16_f32 v25, 0, v49
  v_cvt_pk_bf16_f32 v26, 0, v50
  v_cvt_pk_bf16_f32 v27, 0, v51
  ds_read_b128 v[48:51], v11 offset:768
  v_mul_f32 v24, s66, v24
  v_mul_f32 v25, s66, v25
  v_mul_f32 v26, s66, v26
  v_mul_f32 v27, s66, v27
  v_cvt_pk_bf16_f32 v24, 0, v24
  v_cvt_pk_bf16_f32 v25, 0, v25
  v_cvt_pk_bf16_f32 v26, 0, v26
  v_cvt_pk_bf16_f32 v27, 0, v27
  v_fma_f32 v24, v24, s67, -v4
  v_fma_f32 v25, v25, s67, -v4
  v_fma_f32 v26, v26, s67, -v4
  v_fma_f32 v27, v27, s67, -v4
  v_exp_f32 v24, v24
  v_exp_f32 v25, v25
  v_exp_f32 v26, v26
  v_exp_f32 v27, v27
  v_cvt_pk_bf16_f32 v16, v24, v25
  v_cvt_pk_bf16_f32 v17, v26, v27
  v_perm_b32 v32, v16, v16, v40
  v_perm_b32 v33, v16, v16, v41
  v_perm_b32 v34, v16, v16, v42
  v_perm_b32 v35, v16, v16, v43
  v_perm_b32 v36, v16, v16, v44
  v_perm_b32 v37, v16, v16, v45
  v_perm_b32 v38, v16, v16, v46
  v_perm_b32 v39, v16, v16, v47
  v_add_f32 v7, v24, v25
  v_add_f32 v8, v26, v27
  s_waitcnt vmcnt(4)
  buffer_load_dwordx4 v[204:207], v13, s[44:47], s38 offen offset:3072 nt
  v_mfma_f32_16x16x32_bf16 v[20:23], v[144:147], v[32:35], v[20:23]
  v_perm_b32 v32, v17, v17, v40
  v_perm_b32 v33, v17, v17, v41
  v_perm_b32 v34, v17, v17, v42
  v_perm_b32 v35, v17, v17, v43
  v_mfma_f32_16x16x32_bf16 v[20:23], v[148:151], v[36:39], v[20:23]
  v_perm_b32 v36, v17, v17, v44
  v_perm_b32 v37, v17, v17, v45
  v_perm_b32 v38, v17, v17, v46
  v_perm_b32 v39, v17, v17, v47
  v_mfma_f32_16x16x32_bf16 v[20:23], v[152:155], v[32:35], v[20:23]
  v_add_f32 v5, v5, v7
  v_add_f32 v5, v5, v8
  v_mfma_f32_16x16x32_bf16 v[20:23], v[156:159], v[36:39], v[20:23]
L_he5:
  s_add_u32 s38, s38, 0x4000
  s_waitcnt vmcnt(4)
  buffer_load_dwordx4 v[208:211], v13, s[44:47], s38 offen offset:0 nt
  s_waitcnt lgkmcnt(0)
  v_cvt_pk_bf16_f32 v24, 0, v28
  v_cvt_pk_bf16_f32 v25, 0, v29
  v_cvt_pk_bf16_f32 v26, 0, v30
  v_cvt_pk_bf16_f32 v27, 0, v31
  ds_read_b128 v[28:31], v12 offset:896
  v_mul_f32 v24, s66, v24
  v_mul_f32 v25, s66, v25
  v_mul_f32 v26, s66, v26
  v_mul_f32 v27, s66, v27
  v_cvt_pk_bf16_f32 v24, 0, v24
  v_cvt_pk_bf16_f32 v25, 0, v25
  v_cvt_pk_bf16_f32 v26, 0, v26
  v_cvt_pk_bf16_f32 v27, 0, v27
  v_fma_f32 v24, v24, s67, -v4
  v_fma_f32 v25, v25, s67, -v4
  v_fma_f32 v26, v26, s67, -v4
  v_fma_f32 v27, v27, s67, -v4
  v_exp_f32 v24, v24
  v_exp_f32 v25, v25
  v_exp_f32 v26, v26
  v_exp_f32 v27, v27
  v_cvt_pk_bf16_f32 v16, v24, v25
  v_cvt_pk_bf16_f32 v17, v26, v27
  v_perm_b32 v32, v16, v16, v40
  v_perm_b32 v33, v16, v16, v41
  v_perm_b32 v34, v16, v16, v42
  v_perm_b32 v35, v16, v16, v43
  v_perm_b32 v36, v16, v16, v44
  v_perm_b32 v37, v16, v16, v45
  v_perm_b32 v38, v16, v16, v46
  v_perm_b32 v39, v16, v16, v47
  v_add_f32 v7, v24, v25
  v_add_f32 v8, v26, v27
  s_waitcnt vmcnt(4)
  buffer_load_dwordx4 v[212:215], v13, s[44:47], s38 offen offset:1024 nt
  v_mfma_f32_16x16x32_bf16 v[20:23], v[224:227], v[32:35], v[20:23]
  v_perm_b32 v32, v17, v17, v40
  v_perm_b32 v33, v17, v17, v41
  v_perm_b32 v34, v17, v17, v42
  v_perm_b32 v35, v17, v17, v43
  v_mfma_f32_16x16x32_bf16 v[20:23], v[228:231], v[36:39], v[20:23]
  v_perm_b32 v36, v17, v17, v44
  v_perm_b32 v37, v17, v17, v45
  v_perm_b32 v38, v17, v17, v46
  v_perm_b32 v39, v17, v17, v47
  v_mfma_f32_16x16x32_bf16 v[20:23], v[232:235], v[32:35], v[20:23]
  v_add_f32 v5, v5, v7
  v_add_f32 v5, v5, v8
  v_mfma_f32_16x16x32_bf16 v[20:23], v[236:239], v[36:39], v[20:23]
  s_cmp_eq_u32 s59, 0
  s_cbranch_scc0 L_hb6
  s_waitcnt vmcnt(4)
  buffer_load_dwordx4 v[216:219], v13, s[44:47], s38 offen offset:2048 nt
  s_waitcnt vmcnt(4)
  buffer_load_dwordx4 v[220:223], v13, s[44:47], s38 offen offset:3072 nt
  s_branch L_he6
L_hb6:
  s_waitcnt vmcnt(4)
  buffer_load_dwordx4 v[216:219], v13, s[44:47], s38 offen offset:2048 nt
  s_waitcnt lgkmcnt(0)
  v_cvt_pk_bf16_f32 v24, 0, v48
  v_cvt_pk_bf16_f32 v25, 0, v49
  v_cvt_pk_bf16_f32 v26, 0, v50
  v_cvt_pk_bf16_f32 v27, 0, v51
  ds_read_b128 v[48:51], v11 offset:896
  v_mul_f32 v24, s66, v24
  v_mul_f32 v25, s66, v25
  v_mul_f32 v26, s66, v26
  v_mul_f32 v27, s66, v27
  v_cvt_pk_bf16_f32 v24, 0, v24
  v_cvt_pk_bf16_f32 v25, 0, v25
  v_cvt_pk_bf16_f32 v26, 0, v26
  v_cvt_pk_bf16_f32 v27, 0, v27
  v_fma_f32 v24, v24, s67, -v4
  v_fma_f32 v25, v25, s67, -v4
  v_fma_f32 v26, v26, s67, -v4
  v_fma_f32 v27, v27, s67, -v4
  v_exp_f32 v24, v24
  v_exp_f32 v25, v25
  v_exp_f32 v26, v26
  v_exp_f32 v27, v27
  v_cvt_pk_bf16_f32 v16, v24, v25
  v_cvt_pk_bf16_f32 v17, v26, v27
  v_perm_b32 v32, v16, v16, v40
  v_perm_b32 v33, v16, v16, v41
  v_perm_b32 v34, v16, v16, v42
  v_perm_b32 v35, v16, v16, v43
  v_perm_b32 v36, v16, v16, v44
  v_perm_b32 v37, v16, v16, v45
  v_perm_b32 v38, v16, v16, v46
  v_perm_b32 v39, v16, v16, v47
  v_add_f32 v7, v24, v25
  v_add_f32 v8, v26, v27
  s_waitcnt vmcnt(4)
  buffer_load_dwordx4 v[220:223], v13, s[44:47], s38 offen offset:3072 nt
  v_mfma_f32_16x16x32_bf16 v[20:23], v[160:163], v[32:35], v[20:23]
  v_perm_b32 v32, v17, v17, v40
  v_perm_b32 v33, v17, v17, v41
  v_perm_b32 v34, v17, v17, v42
  v_perm_b32 v35, v17, v17, v43
  v_mfma_f32_16x16x32_bf16 v[20:23], v[164:167], v[36:39], v[20:23]
  v_perm_b32 v36, v17, v17, v44
  v_perm_b32 v37, v17, v17, v45
  v_perm_b32 v38, v17, v17, v46
  v_perm_b32 v39, v17, v17, v47
  v_mfma_f32_16x16x32_bf16 v[20:23], v[168:171], v[32:35], v[20:23]
  v_add_f32 v5, v5, v7
  v_add_f32 v5, v5, v8
  v_mfma_f32_16x16x32_bf16 v[20:23], v[172:175], v[36:39], v[20:23]
L_he6:
  s_add_u32 s38, s38, 0x4000
  s_waitcnt vmcnt(4)
  buffer_load_dwordx4 v[224:227], v13, s[44:47], s38 offen offset:0 nt
  s_waitcnt lgkmcnt(0)
  v_cvt_pk_bf16_f32 v24, 0, v28
  v_cvt_pk_bf16_f32 v25, 0, v29
  v_cvt_pk_bf16_f32 v26, 0, v30
  v_cvt_pk_bf16_f32 v27, 0, v31
  ds_read_b128 v[28:31], v12 offset:1024
  v_mul_f32 v24, s66, v24
  v_mul_f32 v25, s66, v25
  v_mul_f32 v26, s66, v26
  v_mul_f32 v27, s66, v27
  v_cvt_pk_bf16_f32 v24, 0, v24
  v_cvt_pk_bf16_f32 v25, 0, v25
  v_cvt_pk_bf16_f32 v26, 0, v26
  v_cvt_pk_bf16_f32 v27, 0, v27
  v_fma_f32 v24, v24, s67, -v4
  v_fma_f32 v25, v25, s67, -v4
  v_fma_f32 v26, v26, s67, -v4
  v_fma_f32 v27, v27, s67, -v4
  v_exp_f32 v24, v24
  v_exp_f32 v25, v25
  v_exp_f32 v26, v26
  v_exp_f32 v27, v27
  v_cvt_pk_bf16_f32 v16, v24, v25
  v_cvt_pk_bf16_f32 v17, v26, v27
  v_perm_b32 v32, v16, v16, v40
  v_perm_b32 v33, v16, v16, v41
  v_perm_b32 v34, v16, v16, v42
  v_perm_b32 v35, v16, v16, v43
  v_perm_b32 v36, v16, v16, v44
  v_perm_b32 v37, v16, v16, v45
  v_perm_b32 v38, v16, v16, v46
  v_perm_b32 v39, v16, v16, v47
  v_add_f32 v7, v24, v25
  v_add_f32 v8, v26, v27
  s_waitcnt vmcnt(4)
  buffer_load_dwordx4 v[228:231], v13, s[44:47], s38 offen offset:1024 nt
  v_mfma_f32_16x16x32_bf16 v[20:23], v[240:243], v[32:35], v[20:23]
  v_perm_b32 v32, v17, v17, v40
  v_perm_b32 v33, v17, v17, v41
  v_perm_b32 v34, v17, v17, v42
  v_perm_b32 v35, v17, v17, v43
  v_mfma_f32_16x16x32_bf16 v[20:23], v[244:247], v[36:39], v[20:23]
  v_perm_b32 v36, v17, v17, v44
  v_perm_b32 v37, v17, v17, v45
  v_perm_b32 v38, v17, v17, v46
  v_perm_b32 v39, v17, v17, v47
  v_mfma_f32_16x16x32_bf16 v[20:23], v[248:251], v[32:35], v[20:23]
  v_add_f32 v5, v5, v7
  v_add_f32 v5, v5, v8
  v_mfma_f32_16x16x32_bf16 v[20:23], v[252:255], v[36:39], v[20:23]
  s_cmp_eq_u32 s59, 0
  s_cbranch_scc0 L_hb7
  s_waitcnt vmcnt(4)
  buffer_load_dwordx4 v[232:235], v13, s[44:47], s38 offen offset:2048 nt
  s_waitcnt vmcnt(4)
  buffer_load_dwordx4 v[236:239], v13, s[44:47], s38 offen offset:3072 nt
  s_branch L_he7
L_hb7:
  s_waitcnt vmcnt(4)
  buffer_load_dwordx4 v[232:235], v13, s[44:47], s38 offen offset:2048 nt
  s_waitcnt lgkmcnt(0)
  v_cvt_pk_bf16_f32 v24, 0, v48
  v_cvt_pk_bf16_f32 v25, 0, v49
  v_cvt_pk_bf16_f32 v26, 0, v50
  v_cvt_pk_bf16_f32 v27, 0, v51
  v_mul_f32 v24, s66, v24
  v_mul_f32 v25, s66, v25
  v_mul_f32 v26, s66, v26
  v_mul_f32 v27, s66, v27
  v_cvt_pk_bf16_f32 v24, 0, v24
  v_cvt_pk_bf16_f32 v25, 0, v25
  v_cvt_pk_bf16_f32 v26, 0, v26
  v_cvt_pk_bf16_f32 v27, 0, v27
  v_fma_f32 v24, v24, s67, -v4
  v_fma_f32 v25, v25, s67, -v4
  v_fma_f32 v26, v26, s67, -v4
  v_fma_f32 v27, v27, s67, -v4
  v_exp_f32 v24, v24
  v_exp_f32 v25, v25
  v_exp_f32 v26, v26
  v_exp_f32 v27, v27
  v_cvt_pk_bf16_f32 v16, v24, v25
  v_cvt_pk_bf16_f32 v17, v26, v27
  v_perm_b32 v32, v16, v16, v40
  v_perm_b32 v33, v16, v16, v41
  v_perm_b32 v34, v16, v16, v42
  v_perm_b32 v35, v16, v16, v43
  v_perm_b32 v36, v16, v16, v44
  v_perm_b32 v37, v16, v16, v45
  v_perm_b32 v38, v16, v16, v46
  v_perm_b32 v39, v16, v16, v47
  v_add_f32 v7, v24, v25
  v_add_f32 v8, v26, v27
  s_waitcnt vmcnt(4)
  buffer_load_dwordx4 v[236:239], v13, s[44:47], s38 offen offset:3072 nt
  v_mfma_f32_16x16x32_bf16 v[20:23], v[176:179], v[32:35], v[20:23]
  v_perm_b32 v32, v17, v17, v40
  v_perm_b32 v33, v17, v17, v41
  v_perm_b32 v34, v17, v17, v42
  v_perm_b32 v35, v17, v17, v43
  v_mfma_f32_16x16x32_bf16 v[20:23], v[180:183], v[36:39], v[20:23]
  v_perm_b32 v36, v17, v17, v44
  v_perm_b32 v37, v17, v17, v45
  v_perm_b32 v38, v17, v17, v46
  v_perm_b32 v39, v17, v17, v47
  v_mfma_f32_16x16x32_bf16 v[20:23], v[184:187], v[32:35], v[20:23]
  v_add_f32 v5, v5, v7
  v_add_f32 v5, v5, v8
  v_mfma_f32_16x16x32_bf16 v[20:23], v[188:191], v[36:39], v[20:23]
L_he7:
  s_add_u32 s38, s38, 0x4000
  v_add_u32 v12, 1024, v12
  v_lshrrev_b32 v7, 3, v2
  v_lshl_add_u32 v7, v7, 2, v3
  v_lshlrev_b32 v7, 7, v7
  v_and_b32 v8, 7, v2
  v_lshl_add_u32 v9, v8, 4, v7
  v_and_b32 v6, 3, v2
  v_lshlrev_b32 v6, 10, v6
  v_lshrrev_b32 v0, 2, v2
  v_lshl_add_u32 v6, v0, 8, v6
  v_lshl_add_u32 v0, v3, 4, v6
  v_lshrrev_b32 v6, 3, v2
  v_lshlrev_b32 v6, 8, v6
  v_lshl_add_u32 v6, v3, 4, v6
  ds_read_b128 v[48:51], v6 offset:0
  v_lshlrev_b32 v3, 1, v2
  s_mul_i32 s68, s2, 1280
  v_lshlrev_b32 v11, 3, v1
  s_lshl_b32 s64, s37, 9
  v_add_u32 v18, s64, v11
  s_lshl_b32 s64, s37, 10
  v_add_u32 v19, s64, v13
L_vt0:
  s_waitcnt vmcnt(4)
  buffer_load_dwordx4 v[240:243], v13, s[44:47], s38 offen offset:0 nt
  s_waitcnt lgkmcnt(0)
  v_cvt_pk_bf16_f32 v24, 0, v28
  v_cvt_pk_bf16_f32 v25, 0, v29
  v_cvt_pk_bf16_f32 v26, 0, v30
  v_cvt_pk_bf16_f32 v27, 0, v31
  ds_read_b128 v[28:31], v12 offset:128
  v_mul_f32 v24, s66, v24
  v_mul_f32 v25, s66, v25
  v_mul_f32 v26, s66, v26
  v_mul_f32 v27, s66, v27
  v_cvt_pk_bf16_f32 v24, 0, v24
  v_cvt_pk_bf16_f32 v25, 0, v25
  v_cvt_pk_bf16_f32 v26, 0, v26
  v_cvt_pk_bf16_f32 v27, 0, v27
  v_fma_f32 v24, v24, s67, -v4
  v_fma_f32 v25, v25, s67, -v4
  v_fma_f32 v26, v26, s67, -v4
  v_fma_f32 v27, v27, s67, -v4
  v_exp_f32 v24, v24
  v_exp_f32 v25, v25
  v_exp_f32 v26, v26
  v_exp_f32 v27, v27
  s_waitcnt vmcnt(4)
  buffer_load_dwordx4 v[244:247], v13, s[44:47], s38 offen offset:1024 nt
  v_cvt_pk_bf16_f32 v16, v24, v25
  v_cvt_pk_bf16_f32 v17, v26, v27
  v_perm_b32 v32, v16, v16, v40
  v_perm_b32 v33, v16, v16, v41
  v_perm_b32 v34, v16, v16, v42
  v_perm_b32 v35, v16, v16, v43
  v_perm_b32 v36, v16, v16, v44
  v_perm_b32 v37, v16, v16, v45
  v_perm_b32 v38, v16, v16, v46
  v_perm_b32 v39, v16, v16, v47
  v_add_f32 v7, v24, v25
  v_add_f32 v8, v26, v27
  s_waitcnt vmcnt(4)
  buffer_load_dwordx4 v[248:251], v13, s[44:47], s38 offen offset:2048 nt
  v_mfma_f32_16x16x32_bf16 v[20:23], v[192:195], v[32:35], v[20:23]
  v_perm_b32 v32, v17, v17, v40
  v_perm_b32 v33, v17, v17, v41
  v_perm_b32 v34, v17, v17, v42
  v_perm_b32 v35, v17, v17, v43
  v_mfma_f32_16x16x32_bf16 v[20:23], v[196:199], v[36:39], v[20:23]
  v_perm_b32 v36, v17, v17, v44
  v_perm_b32 v37, v17, v17, v45
  v_perm_b32 v38, v17, v17, v46
  v_perm_b32 v39, v17, v17, v47
  v_mfma_f32_16x16x32_bf16 v[20:23], v[200:203], v[32:35], v[20:23]
  v_add_f32 v5, v5, v7
  v_add_f32 v5, v5, v8
  v_mfma_f32_16x16x32_bf16 v[20:23], v[204:207], v[36:39], v[20:23]
  s_waitcnt vmcnt(4)
  buffer_load_dwordx4 v[252:255], v13, s[44:47], s38 offen offset:3072 nt
  s_add_u32 s38, s38, 0x4000
  s_sub_u32 s52, s52, 1
  s_cmp_eq_u32 s52, 0
  s_cbranch_scc1 L_vsw
  s_waitcnt vmcnt(4)
  buffer_load_dwordx4 v[192:195], v13, s[44:47], s38 offen offset:0 nt
  s_waitcnt lgkmcnt(0)
  v_cvt_pk_bf16_f32 v24, 0, v28
  v_cvt_pk_bf16_f32 v25, 0, v29
  v_cvt_pk_bf16_f32 v26, 0, v30
  v_cvt_pk_bf16_f32 v27, 0, v31
  ds_read_b128 v[28:31], v12 offset:256
  v_mul_f32 v24, s66, v24
  v_mul_f32 v25, s66, v25
  v_mul_f32 v26, s66, v26
  v_mul_f32 v27, s66, v27
  v_cvt_pk_bf16_f32 v24, 0, v24
  v_cvt_pk_bf16_f32 v25, 0, v25
  v_cvt_pk_bf16_f32 v26, 0, v26
  v_cvt_pk_bf16_f32 v27, 0, v27
  v_fma_f32 v24, v24, s67, -v4
  v_fma_f32 v25, v25, s67, -v4
  v_fma_f32 v26, v26, s67, -v4
  v_fma_f32 v27, v27, s67, -v4
  v_exp_f32 v24, v24
  v_exp_f32 v25, v25
  v_exp_f32 v26, v26
  v_exp_f32 v27, v27
  s_waitcnt vmcnt(4)
  buffer_load_dwordx4 v[196:199], v13, s[44:47], s38 offen offset:1024 nt
  v_cvt_pk_bf16_f32 v16, v24, v25
  v_cvt_pk_bf16_f32 v17, v26, v27
  v_perm_b32 v32, v16, v16, v40
  v_perm_b32 v33, v16, v16, v41
  v_perm_b32 v34, v16, v16, v42
  v_perm_b32 v35, v16, v16, v43
  v_perm_b32 v36, v16, v16, v44
  v_perm_b32 v37, v16, v16, v45
  v_perm_b32 v38, v16, v16, v46
  v_perm_b32 v39, v16, v16, v47
  v_add_f32 v7, v24, v25
  v_add_f32 v8, v26, v27
  s_waitcnt vmcnt(4)
  buffer_load_dwordx4 v[200:203], v13, s[44:47], s38 offen offset:2048 nt
  v_mfma_f32_16x16x32_bf16 v[20:23], v[208:211], v[32:35], v[20:23]
  v_perm_b32 v32, v17, v17, v40
  v_perm_b32 v33, v17, v17, v41
  v_perm_b32 v34, v17, v17, v42
  v_perm_b32 v35, v17, v17, v43
  v_mfma_f32_16x16x32_bf16 v[20:23], v[212:215], v[36:39], v[20:23]
  v_perm_b32 v36, v17, v17, v44
  v_perm_b32 v37, v17, v17, v45
  v_perm_b32 v38, v17, v17, v46
  v_perm_b32 v39, v17, v17, v47
  v_mfma_f32_16x16x32_bf16 v[20:23], v[216:219], v[32:35], v[20:23]
  v_add_f32 v5, v5, v7
  v_add_f32 v5, v5, v8
  v_mfma_f32_16x16x32_bf16 v[20:23], v[220:223], v[36:39], v[20:23]
  s_waitcnt vmcnt(4)
  buffer_load_dwordx4 v[204:207], v13, s[44:47], s38 offen offset:3072 nt
  s_add_u32 s38, s38, 0x4000
  s_waitcnt vmcnt(4)
  buffer_load_dwordx4 v[208:211], v13, s[44:47], s38 offen offset:0 nt
  s_waitcnt lgkmcnt(0)
  v_cvt_pk_bf16_f32 v24, 0, v28
  v_cvt_pk_bf16_f32 v25, 0, v29
  v_cvt_pk_bf16_f32 v26, 0, v30
  v_cvt_pk_bf16_f32 v27, 0, v31
  ds_read_b128 v[28:31], v12 offset:384
  v_mul_f32 v24, s66, v24
  v_mul_f32 v25, s66, v25
  v_mul_f32 v26, s66, v26
  v_mul_f32 v27, s66, v27
  v_cvt_pk_bf16_f32 v24, 0, v24
  v_cvt_pk_bf16_f32 v25, 0, v25
  v_cvt_pk_bf16_f32 v26, 0, v26
  v_cvt_pk_bf16_f32 v27, 0, v27
  v_fma_f32 v24, v24, s67, -v4
  v_fma_f32 v25, v25, s67, -v4
  v_fma_f32 v26, v26, s67, -v4
  v_fma_f32 v27, v27, s67, -v4
  v_exp_f32 v24, v24
  v_exp_f32 v25, v25
  v_exp_f32 v26, v26
  v_exp_f32 v27, v27
  s_waitcnt vmcnt(4)
  buffer_load_dwordx4 v[212:215], v13, s[44:47], s38 offen offset:1024 nt
  v_cvt_pk_bf16_f32 v16, v24, v25
  v_cvt_pk_bf16_f32 v17, v26, v27
  v_perm_b32 v32, v16, v16, v40
  v_perm_b32 v33, v16, v16, v41
  v_perm_b32 v34, v16, v16, v42
  v_perm_b32 v35, v16, v16, v43
  v_perm_b32 v36, v16, v16, v44
  v_perm_b32 v37, v16, v16, v45
  v_perm_b32 v38, v16, v16, v46
  v_perm_b32 v39, v16, v16, v47
  v_add_f32 v7, v24, v25
  v_add_f32 v8, v26, v27
  s_waitcnt vmcnt(4)
  buffer_load_dwordx4 v[216:219], v13, s[44:47], s38 offen offset:2048 nt
  v_mfma_f32_16x16x32_bf16 v[20:23], v[224:227], v[32:35], v[20:23]
  v_perm_b32 v32, v17, v17, v40
  v_perm_b32 v33, v17, v17, v41
  v_perm_b32 v34, v17, v17, v42
  v_perm_b32 v35, v17, v17, v43
  v_mfma_f32_16x16x32_bf16 v[20:23], v[228:231], v[36:39], v[20:23]
  v_perm_b32 v36, v17, v17, v44
  v_perm_b32 v37, v17, v17, v45
  v_perm_b32 v38, v17, v17, v46
  v_perm_b32 v39, v17, v17, v47
  v_mfma_f32_16x16x32_bf16 v[20:23], v[232:235], v[32:35], v[20:23]
  v_add_f32 v5, v5, v7
  v_add_f32 v5, v5, v8
  v_mfma_f32_16x16x32_bf16 v[20:23], v[236:239], v[36:39], v[20:23]
  s_waitcnt vmcnt(4)
  buffer_load_dwordx4 v[220:223], v13, s[44:47], s38 offen offset:3072 nt
  s_add_u32 s38, s38, 0x4000
  s_waitcnt vmcnt(4)
  buffer_load_dwordx4 v[224:227], v13, s[44:47], s38 offen offset:0 nt
  s_waitcnt lgkmcnt(0)
  v_cvt_pk_bf16_f32 v24, 0, v28
  v_cvt_pk_bf16_f32 v25, 0, v29
  v_cvt_pk_bf16_f32 v26, 0, v30
  v_cvt_pk_bf16_f32 v27, 0, v31
  ds_read_b128 v[28:31], v12 offset:512
  v_mul_f32 v24, s66, v24
  v_mul_f32 v25, s66, v25
  v_mul_f32 v26, s66, v26
  v_mul_f32 v27, s66, v27
  v_cvt_pk_bf16_f32 v24, 0, v24
  v_cvt_pk_bf16_f32 v25, 0, v25
  v_cvt_pk_bf16_f32 v26, 0, v26
  v_cvt_pk_bf16_f32 v27, 0, v27
  v_fma_f32 v24, v24, s67, -v4
  v_fma_f32 v25, v25, s67, -v4
  v_fma_f32 v26, v26, s67, -v4
  v_fma_f32 v27, v27, s67, -v4
  v_exp_f32 v24, v24
  v_exp_f32 v25, v25
  v_exp_f32 v26, v26
  v_exp_f32 v27, v27
  s_waitcnt vmcnt(4)
  buffer_load_dwordx4 v[228:231], v13, s[44:47], s38 offen offset:1024 nt
  v_cvt_pk_bf16_f32 v16, v24, v25
  v_cvt_pk_bf16_f32 v17, v26, v27
  v_perm_b32 v32, v16, v16, v40
  v_perm_b32 v33, v16, v16, v41
  v_perm_b32 v34, v16, v16, v42
  v_perm_b32 v35, v16, v16, v43
  v_perm_b32 v36, v16, v16, v44
  v_perm_b32 v37, v16, v16, v45
  v_perm_b32 v38, v16, v16, v46
  v_perm_b32 v39, v16, v16, v47
  v_add_f32 v7, v24, v25
  v_add_f32 v8, v26, v27
  s_waitcnt vmcnt(4)
  buffer_load_dwordx4 v[232:235], v13, s[44:47], s38 offen offset:2048 nt
  v_mfma_f32_16x16x32_bf16 v[20:23], v[240:243], v[32:35], v[20:23]
  v_perm_b32 v32, v17, v17, v40
  v_perm_b32 v33, v17, v17, v41
  v_perm_b32 v34, v17, v17, v42
  v_perm_b32 v35, v17, v17, v43
  v_mfma_f32_16x16x32_bf16 v[20:23], v[244:247], v[36:39], v[20:23]
  v_perm_b32 v36, v17, v17, v44
  v_perm_b32 v37, v17, v17, v45
  v_perm_b32 v38, v17, v17, v46
  v_perm_b32 v39, v17, v17, v47
  v_mfma_f32_16x16x32_bf16 v[20:23], v[248:251], v[32:35], v[20:23]
  v_add_f32 v5, v5, v7
  v_add_f32 v5, v5, v8
  v_mfma_f32_16x16x32_bf16 v[20:23], v[252:255], v[36:39], v[20:23]
  s_waitcnt vmcnt(4)
  buffer_load_dwordx4 v[236:239], v13, s[44:47], s38 offen offset:3072 nt
  s_add_u32 s38, s38, 0x4000
  v_add_u32 v12, 512, v12
  s_branch L_vt0
L_vsw:
  s_waitcnt vmcnt(4)
  buffer_load_dwordx4 v[64:67], v0, s[40:43], s38 offen offset:0 nt
  s_waitcnt lgkmcnt(0)
  v_cvt_pk_bf16_f32 v24, 0, v28
  v_cvt_pk_bf16_f32 v25, 0, v29
  v_cvt_pk_bf16_f32 v26, 0, v30
  v_cvt_pk_bf16_f32 v27, 0, v31
  ds_read_b128 v[28:31], v12 offset:256
  v_mul_f32 v24, s66, v24
  v_mul_f32 v25, s66, v25
  v_mul_f32 v26, s66, v26
  v_mul_f32 v27, s66, v27
  v_cvt_pk_bf16_f32 v24, 0, v24
  v_cvt_pk_bf16_f32 v25, 0, v25
  v_cvt_pk_bf16_f32 v26, 0, v26
  v_cvt_pk_bf16_f32 v27, 0, v27
  v_fma_f32 v24, v24, s67, -v4
  v_fma_f32 v25, v25, s67, -v4
  v_fma_f32 v26, v26, s67, -v4
  v_fma_f32 v27, v27, s67, -v4
  v_exp_f32 v24, v24
  v_exp_f32 v25, v25
  v_exp_f32 v26, v26
  v_exp_f32 v27, v27
  v_cvt_pk_bf16_f32 v16, v24, v25
  v_cvt_pk_bf16_f32 v17, v26, v27
  v_perm_b32 v32, v16, v16, v40
  v_perm_b32 v33, v16, v16, v41
  v_perm_b32 v34, v16, v16, v42
  v_perm_b32 v35, v16, v16, v43
  v_perm_b32 v36, v16, v16, v44
  v_perm_b32 v37, v16, v16, v45
  v_perm_b32 v38, v16, v16, v46
  v_perm_b32 v39, v16, v16, v47
  v_add_f32 v7, v24, v25
  v_add_f32 v8, v26, v27
  s_waitcnt vmcnt(4)
  buffer_load_dwordx4 v[68:71], v0, s[40:43], s38 offen offset:64 nt
  s_waitcnt vmcnt(13)
  v_mfma_f32_16x16x32_bf16 v[20:23], v[208:211], v[32:35], v[20:23]
  v_perm_b32 v32, v17, v17, v40
  v_perm_b32 v33, v17, v17, v41
  v_perm_b32 v34, v17, v17, v42
  v_perm_b32 v35, v17, v17, v43
  s_waitcnt vmcnt(12)
  v_mfma_f32_16x16x32_bf16 v[20:23], v[212:215], v[36:39], v[20:23]
  v_perm_b32 v36, v17, v17, v44
  v_perm_b32 v37, v17, v17, v45
  v_perm_b32 v38, v17, v17, v46
  v_perm_b32 v39, v17, v17, v47
  s_waitcnt vmcnt(11)
  v_mfma_f32_16x16x32_bf16 v[20:23], v[216:219], v[32:35], v[20:23]
  v_add_f32 v5, v5, v7
  v_add_f32 v5, v5, v8
  s_waitcnt vmcnt(10)
  v_mfma_f32_16x16x32_bf16 v[20:23], v[220:223], v[36:39], v[20:23]
  s_waitcnt vmcnt(4)
  buffer_load_dwordx4 v[72:75], v0, s[40:43], s38 offen offset:128 nt
  s_waitcnt lgkmcnt(0)
  v_cvt_pk_bf16_f32 v24, 0, v28
  v_cvt_pk_bf16_f32 v25, 0, v29
  v_cvt_pk_bf16_f32 v26, 0, v30
  v_cvt_pk_bf16_f32 v27, 0, v31
  ds_read_b128 v[28:31], v12 offset:384
  v_mul_f32 v24, s66, v24
  v_mul_f32 v25, s66, v25
  v_mul_f32 v26, s66, v26
  v_mul_f32 v27, s66, v27
  v_cvt_pk_bf16_f32 v24, 0, v24
  v_cvt_pk_bf16_f32 v25, 0, v25
  v_cvt_pk_bf16_f32 v26, 0, v26
  v_cvt_pk_bf16_f32 v27, 0, v27
  v_fma_f32 v24, v24, s67, -v4
  v_fma_f32 v25, v25, s67, -v4
  v_fma_f32 v26, v26, s67, -v4
  v_fma_f32 v27, v27, s67, -v4
  v_exp_f32 v24, v24
  v_exp_f32 v25, v25
  v_exp_f32 v26, v26
  v_exp_f32 v27, v27
  v_cvt_pk_bf16_f32 v16, v24, v25
  v_cvt_pk_bf16_f32 v17, v26, v27
  v_perm_b32 v32, v16, v16, v40
  v_perm_b32 v33, v16, v16, v41
  v_perm_b32 v34, v16, v16, v42
  v_perm_b32 v35, v16, v16, v43
  v_perm_b32 v36, v16, v16, v44
  v_perm_b32 v37, v16, v16, v45
  v_perm_b32 v38, v16, v16, v46
  v_perm_b32 v39, v16, v16, v47
  v_add_f32 v7, v24, v25
  v_add_f32 v8, v26, v27
  s_waitcnt vmcnt(4)
  buffer_load_dwordx4 v[76:79], v0, s[40:43], s38 offen offset:192 nt
  s_waitcnt vmcnt(11)
  v_mfma_f32_16x16x32_bf16 v[20:23], v[224:227], v[32:35], v[20:23]
  v_perm_b32 v32, v17, v17, v40
  v_perm_b32 v33, v17, v17, v41
  v_perm_b32 v34, v17, v17, v42
  v_perm_b32 v35, v17, v17, v43
  s_waitcnt vmcnt(10)
  v_mfma_f32_16x16x32_bf16 v[20:23], v[228:231], v[36:39], v[20:23]
  v_perm_b32 v36, v17, v17, v44
  v_perm_b32 v37, v17, v17, v45
  v_perm_b32 v38, v17, v17, v46
  v_perm_b32 v39, v17, v17, v47
  s_waitcnt vmcnt(9)
  v_mfma_f32_16x16x32_bf16 v[20:23], v[232:235], v[32:35], v[20:23]
  v_add_f32 v5, v5, v7
  v_add_f32 v5, v5, v8
  s_waitcnt vmcnt(8)
  v_mfma_f32_16x16x32_bf16 v[20:23], v[236:239], v[36:39], v[20:23]
  s_waitcnt vmcnt(4)
  buffer_load_dwordx4 v[80:83], v13, s[44:47], s38 offen offset:0 nt
  s_waitcnt lgkmcnt(0)
  v_cvt_pk_bf16_f32 v24, 0, v28
  v_cvt_pk_bf16_f32 v25, 0, v29
  v_cvt_pk_bf16_f32 v26, 0, v30
  v_cvt_pk_bf16_f32 v27, 0, v31
  v_mul_f32 v24, s66, v24
  v_mul_f32 v25, s66, v25
  v_mul_f32 v26, s66, v26
  v_mul_f32 v27, s66, v27
  v_cvt_pk_bf16_f32 v24, 0, v24
  v_cvt_pk_bf16_f32 v25, 0, v25
  v_cvt_pk_bf16_f32 v26, 0, v26
  v_cvt_pk_bf16_f32 v27, 0, v27
  v_fma_f32 v24, v24, s67, -v4
  v_fma_f32 v25, v25, s67, -v4
  v_fma_f32 v26, v26, s67, -v4
  v_fma_f32 v27, v27, s67, -v4
  v_exp_f32 v24, v24
  v_exp_f32 v25, v25
  v_exp_f32 v26, v26
  v_exp_f32 v27, v27
  s_waitcnt vmcnt(4)
  buffer_load_dwordx4 v[84:87], v13, s[44:47], s38 offen offset:1024 nt
  v_cvt_pk_bf16_f32 v16, v24, v25
  v_cvt_pk_bf16_f32 v17, v26, v27
  v_perm_b32 v32, v16, v16, v40
  v_perm_b32 v33, v16, v16, v41
  v_perm_b32 v34, v16, v16, v42
  v_perm_b32 v35, v16, v16, v43
  v_perm_b32 v36, v16, v16, v44
  v_perm_b32 v37, v16, v16, v45
  v_perm_b32 v38, v16, v16, v46
  v_perm_b32 v39, v16, v16, v47
  v_add_f32 v7, v24, v25
  v_add_f32 v8, v26, v27
  s_waitcnt vmcnt(4)
  buffer_load_dwordx4 v[88:91], v13, s[44:47], s38 offen offset:2048 nt
  s_waitcnt vmcnt(10)
  v_mfma_f32_16x16x32_bf16 v[20:23], v[240:243], v[32:35], v[20:23]
  v_perm_b32 v32, v17, v17, v40
  v_perm_b32 v33, v17, v17, v41
  v_perm_b32 v34, v17, v17, v42
  v_perm_b32 v35, v17, v17, v43
  s_waitcnt vmcnt(9)
  v_mfma_f32_16x16x32_bf16 v[20:23], v[244:247], v[36:39], v[20:23]
  v_perm_b32 v36, v17, v17, v44
  v_perm_b32 v37, v17, v17, v45
  v_perm_b32 v38, v17, v17, v46
  v_perm_b32 v39, v17, v17, v47
  s_waitcnt vmcnt(8)
  v_mfma_f32_16x16x32_bf16 v[20:23], v[248:251], v[32:35], v[20:23]
  v_add_f32 v5, v5, v7
  v_add_f32 v5, v5, v8
  s_waitcnt vmcnt(7)
  v_mfma_f32_16x16x32_bf16 v[20:23], v[252:255], v[36:39], v[20:23]
  s_waitcnt vmcnt(4)
  buffer_load_dwordx4 v[92:95], v13, s[44:47], s38 offen offset:3072 nt
  s_mov_b64 exec, 1
  ds_add_rtn_u32 v28, v14, v15 offset:528
  s_mov_b64 exec, -1
L_sloop:
  s_mov_b64 exec, 1
  s_waitcnt lgkmcnt(0)
  v_lshlrev_b32 v28, 2, v28
L_qt0:
  ds_read_b32 v29, v28 offset:576
  s_waitcnt lgkmcnt(0)
  v_readfirstlane_b32 s64, v29
  s_nop 0
  s_cmp_eq_u32 s64, 0
  s_cbranch_scc1 L_qt0
  s_mov_b64 exec, -1
  s_mov_b32 s58, s64
  s_waitcnt vmcnt(4)
  buffer_load_dwordx4 v[96:99], v0, s[40:43], s58 offen offset:0 nt
  buffer_load_dwordx4 v[100:103], v0, s[40:43], s58 offen offset:64 nt
  buffer_load_dwordx4 v[104:107], v0, s[40:43], s58 offen offset:128 nt
  buffer_load_dwordx4 v[108:111], v0, s[40:43], s58 offen offset:192 nt
  s_waitcnt vmcnt(8)
  v_mfma_f32_16x16x32_bf16 v[24:27], v[64:67], v[48:51], 0
  v_mfma_f32_16x16x32_bf16 v[24:27], v[68:71], v[52:55], v[24:27]
  v_mfma_f32_16x16x32_bf16 v[24:27], v[72:75], v[56:59], v[24:27]
  v_mfma_f32_16x16x32_bf16 v[24:27], v[76:79], v[60:63], v[24:27]
  s_nop 7
  v_cvt_pk_bf16_f32 v24, 0, v24
  v_cvt_pk_bf16_f32 v25, 0, v25
  v_cvt_pk_bf16_f32 v26, 0, v26
  v_cvt_pk_bf16_f32 v27, 0, v27
  v_mul_f32 v24, s66, v24
  v_mul_f32 v25, s66, v25
  v_mul_f32 v26, s66, v26
  v_mul_f32 v27, s66, v27
  v_cvt_pk_bf16_f32 v24, 0, v24
  v_cvt_pk_bf16_f32 v25, 0, v25
  v_cvt_pk_bf16_f32 v26, 0, v26
  v_cvt_pk_bf16_f32 v27, 0, v27
  v_max3_f32 v7, v24, v25, v26
  v_max_f32 v7, v7, v27
  v_mov_b32 v8, v7
  s_nop 1
  v_permlane16_swap_b32 v7, v8
  v_max_f32 v7, v7, v8
  v_mov_b32 v8, v7
  s_nop 1
  v_permlane32_swap_b32 v7, v8
  v_max_f32 v7, v7, v8
  v_mul_f32 v7, s67, v7
  v_max_f32 v7, v7, v4
  v_sub_f32 v6, v4, v7
  v_mov_b32 v4, v7
  v_exp_f32 v6, v6
  v_fma_f32 v24, v24, s67, -v4
  v_fma_f32 v25, v25, s67, -v4
  v_fma_f32 v26, v26, s67, -v4
  v_fma_f32 v27, v27, s67, -v4
  v_exp_f32 v24, v24
  v_exp_f32 v25, v25
  v_exp_f32 v26, v26
  v_exp_f32 v27, v27
  v_mul_f32 v20, v6, v20
  v_mul_f32 v21, v6, v21
  v_mul_f32 v22, v6, v22
  v_mul_f32 v23, v6, v23
  v_cvt_pk_bf16_f32 v16, v24, v25
  v_cvt_pk_bf16_f32 v17, v26, v27
  v_perm_b32 v32, v16, v16, v40
  v_perm_b32 v33, v16, v16, v41
  v_perm_b32 v34, v16, v16, v42
  v_perm_b32 v35, v16, v16, v43
  v_fma_f32 v5, v5, v6, v24
  v_add_f32 v7, v25, v26
  v_perm_b32 v36, v16, v16, v44
  v_perm_b32 v37, v16, v16, v45
  v_perm_b32 v38, v16, v16, v46
  v_perm_b32 v39, v16, v16, v47
  s_cmp_eq_u32 s58, 8388608
  s_waitcnt vmcnt(4)
  s_cbranch_scc1 L_pv0
  buffer_load_dwordx4 v[112:115], v13, s[44:47], s58 offen offset:0 nt
  buffer_load_dwordx4 v[116:119], v13, s[44:47], s58 offen offset:1024 nt
  buffer_load_dwordx4 v[120:123], v13, s[44:47], s58 offen offset:2048 nt
  buffer_load_dwordx4 v[124:127], v13, s[44:47], s58 offen offset:3072 nt
  s_mov_b64 exec, 1
  ds_add_rtn_u32 v28, v14, v15 offset:528
  s_mov_b64 exec, -1
L_pv0:
  v_mfma_f32_16x16x32_bf16 v[20:23], v[80:83], v[32:35], v[20:23]
  v_perm_b32 v32, v17, v17, v40
  v_perm_b32 v33, v17, v17, v41
  v_perm_b32 v34, v17, v17, v42
  v_perm_b32 v35, v17, v17, v43
  v_mfma_f32_16x16x32_bf16 v[20:23], v[84:87], v[36:39], v[20:23]
  v_perm_b32 v36, v17, v17, v44
  v_perm_b32 v37, v17, v17, v45
  v_perm_b32 v38, v17, v17, v46
  v_perm_b32 v39, v17, v17, v47
  v_mfma_f32_16x16x32_bf16 v[20:23], v[88:91], v[32:35], v[20:23]
  v_add_f32 v5, v5, v27
  v_add_f32 v5, v5, v7
  v_mfma_f32_16x16x32_bf16 v[20:23], v[92:95], v[36:39], v[20:23]
  s_cmp_eq_u32 s58, 8388608
  s_cbranch_scc1 L_sdone
  s_mov_b64 exec, 1
  s_waitcnt lgkmcnt(0)
  v_lshlrev_b32 v28, 2, v28
L_qt1:
  ds_read_b32 v29, v28 offset:576
  s_waitcnt lgkmcnt(0)
  v_readfirstlane_b32 s64, v29
  s_nop 0
  s_cmp_eq_u32 s64, 0
  s_cbranch_scc1 L_qt1
  s_mov_b64 exec, -1
  s_mov_b32 s58, s64
  s_waitcnt vmcnt(4)
  buffer_load_dwordx4 v[64:67], v0, s[40:43], s58 offen offset:0 nt
  buffer_load_dwordx4 v[68:71], v0, s[40:43], s58 offen offset:64 nt
  buffer_load_dwordx4 v[72:75], v0, s[40:43], s58 offen offset:128 nt
  buffer_load_dwordx4 v[76:79], v0, s[40:43], s58 offen offset:192 nt
  s_waitcnt vmcnt(8)
  v_mfma_f32_16x16x32_bf16 v[24:27], v[96:99], v[48:51], 0
  v_mfma_f32_16x16x32_bf16 v[24:27], v[100:103], v[52:55], v[24:27]
  v_mfma_f32_16x16x32_bf16 v[24:27], v[104:107], v[56:59], v[24:27]
  v_mfma_f32_16x16x32_bf16 v[24:27], v[108:111], v[60:63], v[24:27]
  s_nop 7
  v_cvt_pk_bf16_f32 v24, 0, v24
  v_cvt_pk_bf16_f32 v25, 0, v25
  v_cvt_pk_bf16_f32 v26, 0, v26
  v_cvt_pk_bf16_f32 v27, 0, v27
  v_mul_f32 v24, s66, v24
  v_mul_f32 v25, s66, v25
  v_mul_f32 v26, s66, v26
  v_mul_f32 v27, s66, v27
  v_cvt_pk_bf16_f32 v24, 0, v24
  v_cvt_pk_bf16_f32 v25, 0, v25
  v_cvt_pk_bf16_f32 v26, 0, v26
  v_cvt_pk_bf16_f32 v27, 0, v27
  v_max3_f32 v7, v24, v25, v26
  v_max_f32 v7, v7, v27
  v_mov_b32 v8, v7
  s_nop 1
  v_permlane16_swap_b32 v7, v8
  v_max_f32 v7, v7, v8
  v_mov_b32 v8, v7
  s_nop 1
  v_permlane32_swap_b32 v7, v8
  v_max_f32 v7, v7, v8
  v_mul_f32 v7, s67, v7
  v_max_f32 v7, v7, v4
  v_sub_f32 v6, v4, v7
  v_mov_b32 v4, v7
  v_exp_f32 v6, v6
  v_fma_f32 v24, v24, s67, -v4
  v_fma_f32 v25, v25, s67, -v4
  v_fma_f32 v26, v26, s67, -v4
  v_fma_f32 v27, v27, s67, -v4
  v_exp_f32 v24, v24
  v_exp_f32 v25, v25
  v_exp_f32 v26, v26
  v_exp_f32 v27, v27
  v_mul_f32 v20, v6, v20
  v_mul_f32 v21, v6, v21
  v_mul_f32 v22, v6, v22
  v_mul_f32 v23, v6, v23
  v_cvt_pk_bf16_f32 v16, v24, v25
  v_cvt_pk_bf16_f32 v17, v26, v27
  v_perm_b32 v32, v16, v16, v40
  v_perm_b32 v33, v16, v16, v41
  v_perm_b32 v34, v16, v16, v42
  v_perm_b32 v35, v16, v16, v43
  v_fma_f32 v5, v5, v6, v24
  v_add_f32 v7, v25, v26
  v_perm_b32 v36, v16, v16, v44
  v_perm_b32 v37, v16, v16, v45
  v_perm_b32 v38, v16, v16, v46
  v_perm_b32 v39, v16, v16, v47
  s_cmp_eq_u32 s58, 8388608
  s_waitcnt vmcnt(4)
  s_cbranch_scc1 L_pv1
  buffer_load_dwordx4 v[80:83], v13, s[44:47], s58 offen offset:0 nt
  buffer_load_dwordx4 v[84:87], v13, s[44:47], s58 offen offset:1024 nt
  buffer_load_dwordx4 v[88:91], v13, s[44:47], s58 offen offset:2048 nt
  buffer_load_dwordx4 v[92:95], v13, s[44:47], s58 offen offset:3072 nt
  s_mov_b64 exec, 1
  ds_add_rtn_u32 v28, v14, v15 offset:528
  s_mov_b64 exec, -1
L_pv1:
  v_mfma_f32_16x16x32_bf16 v[20:23], v[112:115], v[32:35], v[20:23]
  v_perm_b32 v32, v17, v17, v40
  v_perm_b32 v33, v17, v17, v41
  v_perm_b32 v34, v17, v17, v42
  v_perm_b32 v35, v17, v17, v43
  v_mfma_f32_16x16x32_bf16 v[20:23], v[116:119], v[36:39], v[20:23]
  v_perm_b32 v36, v17, v17, v44
  v_perm_b32 v37, v17, v17, v45
  v_perm_b32 v38, v17, v17, v46
  v_perm_b32 v39, v17, v17, v47
  v_mfma_f32_16x16x32_bf16 v[20:23], v[120:123], v[32:35], v[20:23]
  v_add_f32 v5, v5, v27
  v_add_f32 v5, v5, v7
  v_mfma_f32_16x16x32_bf16 v[20:23], v[124:127], v[36:39], v[20:23]
  s_cmp_eq_u32 s58, 8388608
  s_cbranch_scc0 L_sloop
L_sdone:
  v_mov_b32 v8, v5
  s_nop 1
  v_permlane16_swap_b32 v5, v8
  v_add_f32 v5, v5, v8
  v_mov_b32 v8, v5
  s_nop 1
  v_permlane32_swap_b32 v5, v8
  v_add_f32 v5, v5, v8
  ds_write_b64 v18, v[4:5] offset:12032
  ds_write_b128 v19, v[20:23] offset:7936
  s_mov_b64 exec, 1
  ds_add_rtn_u32 v8, v14, v15 offset:548
  s_mov_b64 exec, -1
  ds_read_b64 v[32:33], v11 offset:12032
  ds_read_b64 v[34:35], v11 offset:12544
  ds_read_b64 v[36:37], v11 offset:13056
  ds_read_b64 v[38:39], v11 offset:13568
  ds_read_b128 v[48:51], v13 offset:7936
  ds_read_b128 v[52:55], v13 offset:8960
  ds_read_b128 v[56:59], v13 offset:9984
  ds_read_b128 v[60:63], v13 offset:11008
  s_and_b32 s64, s56, 0xff
  s_movk_i32 s65, 0xff
  v_mov_b32 v16, s64
  v_mov_b32 v7, s56
  s_waitcnt lgkmcnt(4)
  v_readfirstlane_b32 s64, v8
  v_max_f32 v4, v32, v34
  s_cmp_lg_u32 s64, 3
  s_cbranch_scc1 L_send
  v_max3_f32 v4, v4, v36, v38
  v_sub_f32 v24, v32, v4
  v_sub_f32 v25, v34, v4
  v_sub_f32 v26, v36, v4
  v_sub_f32 v27, v38, v4
  v_exp_f32 v24, v24
  v_exp_f32 v25, v25
  v_exp_f32 v26, v26
  v_exp_f32 v27, v27
  v_mov_b32 v5, s56
  v_mul_f32 v6, v24, v33
  v_fmac_f32 v6, v25, v35
  v_fmac_f32 v6, v26, v37
  v_fmac_f32 v6, v27, v39
  s_mov_b64 exec, 0x0101
  buffer_store_dwordx4 v[4:7], v3, s[48:51], s68 offen offset:1024 sc1
  s_mov_b64 exec, -1
  s_waitcnt lgkmcnt(0)
  v_mul_f32 v20, v24, v48
  v_mul_f32 v21, v24, v49
  v_mul_f32 v22, v24, v50
  v_mul_f32 v23, v24, v51
  v_fmac_f32 v20, v25, v52
  v_fmac_f32 v21, v25, v53
  v_fmac_f32 v22, v25, v54
  v_fmac_f32 v23, v25, v55
  v_fmac_f32 v20, v26, v56
  v_fmac_f32 v21, v26, v57
  v_fmac_f32 v22, v26, v58
  v_fmac_f32 v23, v26, v59
  v_fmac_f32 v20, v27, v60
  v_fmac_f32 v21, v27, v61
  v_fmac_f32 v22, v27, v62
  v_fmac_f32 v23, v27, v63
  v_bfi_b32 v20, s65, v16, v20
  v_bfi_b32 v21, s65, v16, v21
  v_bfi_b32 v22, s65, v16, v22
  v_bfi_b32 v23, s65, v16, v23
  buffer_store_dwordx4 v[20:23], v9, s[48:51], s68 offen sc1
  s_barrier
L_send:
  s_endpgm
L_helper:
  s_setprio 2
  v_lshlrev_b32 v11, 4, v1
  v_mov_b32 v12, 0
  v_lshlrev_b32 v23, 2, v1
  ds_write_b32 v23, v12 offset:512
  ds_write_b32 v23, v12 offset:768
  ds_write_b32 v23, v12 offset:1024
  s_lshr_b32 s33, s31, 4
  s_and_b32 s34, s31, 15
  s_and_b32 s35, s2, 127
  s_sub_u32 s64, s32, s31
  s_and_b32 s64, s64, 7
  s_lshr_b32 s65, s64, 2
  s_lshl_b32 s72, s31, 1
  s_add_u32 s72, s72, s65
  s_lshl_b32 s73, s65, 4
  s_add_u32 s73, s73, s34
  s_and_b32 s64, s64, 3
  s_cmp_lt_u32 s73, 18
  s_cselect_b32 s3, 2, 0
  s_cmp_eq_u32 s64, 2
  s_cselect_b32 s3, s3, 0
  s_cmp_eq_u32 s64, 0
  s_cselect_b32 s3, 1, s3
  v_mul_u32_u24 v13, 36, v1
  s_mov_b32 s42, 2304
  s_mov_b32 s43, 0x20000
  s_mov_b32 s46, 4718592
  s_mov_b32 s47, 0x20000
  v_lshrrev_b32 v14, 3, v1
  v_lshlrev_b32 v14, 13, v14
  v_and_b32 v15, 7, v1
  v_lshrrev_b32 v16, 3, v1
  v_and_b32 v16, 2, v16
  v_xor_b32 v15, v15, v16
  v_lshl_add_u32 v14, v15, 4, v14
  v_xor_b32 v31, 64, v14
  s_mul_i32 s38, s30, 1179648
  s_lshl_b32 s64, s72, 7
  s_add_u32 s38, s38, s64
  s_mul_i32 s37, s30, 18432
  s_add_u32 s37, s37, 14336
  s_lshl_b32 s64, s30, 2
  s_add_u32 s64, s64, s3
  s_cmp_eq_u32 s64, 2
  s_cselect_b32 s70, 1, 0
  s_cmp_eq_u32 s3, 1
  s_cselect_b32 s70, 1, s70
  s_waitcnt lgkmcnt(0)
  s_mov_b32 s48, s28
  s_mov_b32 s49, s29
  s_mov_b32 s40, s4
  s_mov_b32 s41, s5
  s_mov_b32 s44, s10
  s_mov_b32 s45, s11
  s_mov_b32 s64, 974848
  s_load_dwordx2 s[78:79], s[28:29], s64
  s_cmp_eq_u32 s70, 0
  s_cbranch_scc1 L_h_x
  buffer_load_dwordx4 v[64:67], v13, s[40:43], 0 offen
  buffer_load_dwordx4 v[68:71], v13, s[40:43], 0 offen offset:16
  buffer_load_dword v72, v13, s[40:43], 0 offen offset:32
  s_cmp_lg_u32 s3, 1
  s_cbranch_scc1 L_h_x
  s_mov_b32 m0, s37
  s_add_u32 s37, s37, 1024
  buffer_load_dwordx4 v14, s[44:47], s38 offen nt lds
  s_add_u32 s38, s38, 0x10000
  s_mov_b32 m0, s37
  s_add_u32 s37, s37, 1024
  buffer_load_dwordx4 v31, s[44:47], s38 offen nt lds
  s_add_u32 s38, s38, 0x10000
  s_mov_b32 m0, s37
  s_add_u32 s37, s37, 1024
  buffer_load_dwordx4 v14, s[44:47], s38 offen nt lds
  s_add_u32 s38, s38, 0x10000
  s_mov_b32 m0, s37
  s_add_u32 s37, s37, 1024
  buffer_load_dwordx4 v31, s[44:47], s38 offen nt lds
  s_add_u32 s38, s38, 0x10000
  s_mov_b32 m0, s37
  s_add_u32 s37, s37, 1024
  buffer_load_dwordx4 v14, s[44:47], s38 offen nt lds
  s_add_u32 s38, s38, 0x10000
  s_mov_b32 m0, s37
  s_add_u32 s37, s37, 1024
  buffer_load_dwordx4 v31, s[44:47], s38 offen nt lds
  s_add_u32 s38, s38, 0x10000
  s_mov_b32 m0, s37
  s_add_u32 s37, s37, 1024
  buffer_load_dwordx4 v14, s[44:47], s38 offen nt lds
  s_add_u32 s38, s38, 0x10000
  s_mov_b32 m0, s37
  s_add_u32 s37, s37, 1024
  buffer_load_dwordx4 v31, s[44:47], s38 offen nt lds
  s_add_u32 s38, s38, 0x10000
  s_mov_b32 m0, s37
  s_add_u32 s37, s37, 1024
  buffer_load_dwordx4 v14, s[44:47], s38 offen nt lds
  s_add_u32 s38, s38, 0x10000
  s_mov_b32 m0, s37
  s_add_u32 s37, s37, 1024
  buffer_load_dwordx4 v31, s[44:47], s38 offen nt lds
  s_add_u32 s38, s38, 0x10000
  s_mov_b32 m0, s37
  s_add_u32 s37, s37, 1024
  buffer_load_dwordx4 v14, s[44:47], s38 offen nt lds
  s_add_u32 s38, s38, 0x10000
  s_mov_b32 m0, s37
  s_add_u32 s37, s37, 1024
  buffer_load_dwordx4 v31, s[44:47], s38 offen nt lds
  s_add_u32 s38, s38, 0x10000
  s_mov_b32 m0, s37
  s_add_u32 s37, s37, 1024
  buffer_load_dwordx4 v14, s[44:47], s38 offen nt lds
  s_add_u32 s38, s38, 0x10000
  s_mov_b32 m0, s37
  s_add_u32 s37, s37, 1024
  buffer_load_dwordx4 v31, s[44:47], s38 offen nt lds
  s_add_u32 s38, s38, 0x10000
  s_mov_b32 m0, s37
  s_add_u32 s37, s37, 1024
  buffer_load_dwordx4 v14, s[44:47], s38 offen nt lds
  s_add_u32 s38, s38, 0x10000
  s_mov_b32 m0, s37
  s_add_u32 s37, s37, 1024
  buffer_load_dwordx4 v31, s[44:47], s38 offen nt lds
  s_add_u32 s38, s38, 0x10000
  s_mov_b32 m0, s37
  s_add_u32 s37, s37, 1024
  buffer_load_dwordx4 v14, s[44:47], s38 offen nt lds
  s_add_u32 s38, s38, 0x10000
  s_mov_b32 m0, s37
  s_add_u32 s37, s37, 1024
  buffer_load_dwordx4 v31, s[44:47], s38 offen nt lds
  s_add_u32 s38, s38, 0x10000
L_h_x:
  s_barrier
  s_cmp_eq_u32 s70, 0
  s_cbranch_scc1 L_h_noln
  v_and_b32 v15, 1, v2
  v_mul_u32_u24 v15, 1152, v15
  v_lshl_add_u32 v15, v3, 4, v15
  v_lshrrev_b32 v16, 2, v2
  v_lshl_add_u32 v16, v3, 3, v16
  v_lshlrev_b32 v16, 7, v16
  v_and_b32 v17, 3, v1
  v_lshl_add_u32 v16, v17, 3, v16
  s_lshl_b32 s64, s30, 5
  v_add_u32 v16, s64, v16
  v_lshlrev_b32 v17, 2, v1
  v_and_b32 v17, 0x60, v17
  v_xor_b32 v16, v16, v17
  v_add_u32 v20, 0x8000, v16
  v_lshlrev_b32 v17, 2, v2
  v_lshl_add_u32 v17, v3, 14, v17
  s_lshl_b32 s39, s72, 8
  s_lshl_b32 s64, s30, 6
  s_add_u32 s39, s39, s64
  s_add_u32 s39, s39, 942080
  s_cmp_eq_u32 s3, 1
  s_cbranch_scc1 L_h_wx
  s_waitcnt vmcnt(0)
L_h_wx:
  s_waitcnt vmcnt(18)
  v_lshlrev_b32 v80, 16, v64
  v_and_b32 v81, 0xffff0000, v64
  v_lshlrev_b32 v82, 16, v65
  v_and_b32 v83, 0xffff0000, v65
  v_lshlrev_b32 v84, 16, v66
  v_and_b32 v85, 0xffff0000, v66
  v_lshlrev_b32 v86, 16, v67
  v_and_b32 v87, 0xffff0000, v67
  v_lshlrev_b32 v88, 16, v68
  v_and_b32 v89, 0xffff0000, v68
  v_lshlrev_b32 v90, 16, v69
  v_and_b32 v91, 0xffff0000, v69
  v_lshlrev_b32 v92, 16, v70
  v_and_b32 v93, 0xffff0000, v70
  v_lshlrev_b32 v94, 16, v71
  v_and_b32 v95, 0xffff0000, v71
  v_lshlrev_b32 v96, 16, v72
  v_and_b32 v97, 0xffff0000, v72
  v_add_f32 v116, v80, v81
  v_add_f32 v117, v82, v83
  v_add_f32 v116, v116, v84
  v_add_f32 v117, v117, v85
  v_add_f32 v116, v116, v86
  v_add_f32 v117, v117, v87
  v_add_f32 v116, v116, v88
  v_add_f32 v117, v117, v89
  v_add_f32 v116, v116, v90
  v_add_f32 v117, v117, v91
  v_add_f32 v116, v116, v92
  v_add_f32 v117, v117, v93
  v_add_f32 v116, v116, v94
  v_add_f32 v117, v117, v95
  v_add_f32 v116, v116, v96
  v_add_f32 v117, v117, v97
  v_add_f32 v116, v116, v117
  s_nop 1
  v_add_f32_dpp v116, v116, v116 quad_perm:[1,0,3,2] row_mask:0xf bank_mask:0xf
  s_nop 1
  v_add_f32_dpp v116, v116, v116 quad_perm:[2,3,0,1] row_mask:0xf bank_mask:0xf
  s_nop 1
  v_add_f32_dpp v116, v116, v116 row_half_mirror row_mask:0xf bank_mask:0xf
  s_nop 1
  v_add_f32_dpp v116, v116, v116 row_mirror row_mask:0xf bank_mask:0xf
  v_mov_b32 v117, v116
  s_nop 1
  v_permlane16_swap_b32 v116, v117
  v_add_f32 v116, v116, v117
  v_mul_f32 v116, 0x3ae38e39, v116
  v_sub_f32 v98, v80, v116
  v_sub_f32 v99, v81, v116
  v_sub_f32 v100, v82, v116
  v_sub_f32 v101, v83, v116
  v_sub_f32 v102, v84, v116
  v_sub_f32 v103, v85, v116
  v_sub_f32 v104, v86, v116
  v_sub_f32 v105, v87, v116
  v_sub_f32 v106, v88, v116
  v_sub_f32 v107, v89, v116
  v_sub_f32 v108, v90, v116
  v_sub_f32 v109, v91, v116
  v_sub_f32 v110, v92, v116
  v_sub_f32 v111, v93, v116
  v_sub_f32 v112, v94, v116
  v_sub_f32 v113, v95, v116
  v_sub_f32 v114, v96, v116
  v_sub_f32 v115, v97, v116
  v_mul_f32 v117, v98, v98
  v_mul_f32 v118, v99, v99
  v_fmac_f32 v117, v100, v100
  v_fmac_f32 v118, v101, v101
  v_fmac_f32 v117, v102, v102
  v_fmac_f32 v118, v103, v103
  v_fmac_f32 v117, v104, v104
  v_fmac_f32 v118, v105, v105
  v_fmac_f32 v117, v106, v106
  v_fmac_f32 v118, v107, v107
  v_fmac_f32 v117, v108, v108
  v_fmac_f32 v118, v109, v109
  v_fmac_f32 v117, v110, v110
  v_fmac_f32 v118, v111, v111
  v_fmac_f32 v117, v112, v112
  v_fmac_f32 v118, v113, v113
  v_fmac_f32 v117, v114, v114
  v_fmac_f32 v118, v115, v115
  v_add_f32 v117, v117, v118
  v_cvt_pk_bf16_f32 v116, 0, v116
  s_nop 1
  v_add_f32_dpp v117, v117, v117 quad_perm:[1,0,3,2] row_mask:0xf bank_mask:0xf
  s_nop 1
  v_add_f32_dpp v117, v117, v117 quad_perm:[2,3,0,1] row_mask:0xf bank_mask:0xf
  s_nop 1
  v_add_f32_dpp v117, v117, v117 row_half_mirror row_mask:0xf bank_mask:0xf
  s_nop 1
  v_add_f32_dpp v117, v117, v117 row_mirror row_mask:0xf bank_mask:0xf
  v_mov_b32 v118, v117
  s_nop 1
  v_permlane16_swap_b32 v117, v118
  v_add_f32 v117, v117, v118
  v_mul_f32 v117, 0x3ae38e39, v117
  v_cvt_pk_bf16_f32 v117, 0, v117
  v_add_f32 v117, 0x3727c5ac, v117
  v_cvt_pk_bf16_f32 v117, 0, v117
  v_sqrt_f32 v117, v117
  v_sub_f32 v98, v80, v116
  v_cvt_pk_bf16_f32 v117, 0, v117
  v_rcp_f32 v117, v117
  v_sub_f32 v99, v81, v116
  v_sub_f32 v100, v82, v116
  v_sub_f32 v101, v83, v116
  v_sub_f32 v102, v84, v116
  v_sub_f32 v103, v85, v116
  v_sub_f32 v104, v86, v116
  v_sub_f32 v105, v87, v116
  v_sub_f32 v106, v88, v116
  v_sub_f32 v107, v89, v116
  v_sub_f32 v108, v90, v116
  v_sub_f32 v109, v91, v116
  v_sub_f32 v110, v92, v116
  v_sub_f32 v111, v93, v116
  v_sub_f32 v112, v94, v116
  v_sub_f32 v113, v95, v116
  v_sub_f32 v114, v96, v116
  v_sub_f32 v115, v97, v116
  v_cvt_pk_bf16_f32 v98, 0, v98
  v_cvt_pk_bf16_f32 v99, 0, v99
  v_cvt_pk_bf16_f32 v100, 0, v100
  v_cvt_pk_bf16_f32 v101, 0, v101
  v_cvt_pk_bf16_f32 v102, 0, v102
  v_cvt_pk_bf16_f32 v103, 0, v103
  v_cvt_pk_bf16_f32 v104, 0, v104
  v_cvt_pk_bf16_f32 v105, 0, v105
  v_cvt_pk_bf16_f32 v106, 0, v106
  v_cvt_pk_bf16_f32 v107, 0, v107
  v_cvt_pk_bf16_f32 v108, 0, v108
  v_cvt_pk_bf16_f32 v109, 0, v109
  v_cvt_pk_bf16_f32 v110, 0, v110
  v_cvt_pk_bf16_f32 v111, 0, v111
  v_cvt_pk_bf16_f32 v112, 0, v112
  v_cvt_pk_bf16_f32 v113, 0, v113
  v_cvt_pk_bf16_f32 v114, 0, v114
  v_cvt_pk_bf16_f32 v115, 0, v115
  v_mul_f32 v98, v98, v117
  v_mul_f32 v99, v99, v117
  v_mul_f32 v100, v100, v117
  v_mul_f32 v101, v101, v117
  v_mul_f32 v102, v102, v117
  v_mul_f32 v103, v103, v117
  v_mul_f32 v104, v104, v117
  v_mul_f32 v105, v105, v117
  v_mul_f32 v106, v106, v117
  v_mul_f32 v107, v107, v117
  v_mul_f32 v108, v108, v117
  v_mul_f32 v109, v109, v117
  v_mul_f32 v110, v110, v117
  v_mul_f32 v111, v111, v117
  v_mul_f32 v112, v112, v117
  v_mul_f32 v113, v113, v117
  v_mul_f32 v114, v114, v117
  v_mul_f32 v115, v115, v117
  v_cvt_pk_bf16_f32 v64, v98, v99
  v_cvt_pk_bf16_f32 v65, v100, v101
  v_cvt_pk_bf16_f32 v66, v102, v103
  v_cvt_pk_bf16_f32 v67, v104, v105
  v_cvt_pk_bf16_f32 v68, v106, v107
  v_cvt_pk_bf16_f32 v69, v108, v109
  v_cvt_pk_bf16_f32 v70, v110, v111
  v_cvt_pk_bf16_f32 v71, v112, v113
  v_cvt_pk_bf16_f32 v72, v114, v115
  v_mov_b32 v18, 1
  s_cmp_lg_u32 s3, 1
  s_cbranch_scc1 L_h_ln2
  ds_write_b32 v13, v64 offset:3328
  ds_write_b32 v13, v65 offset:3332
  ds_write_b32 v13, v66 offset:3336
  ds_write_b32 v13, v67 offset:3340
  ds_write_b32 v13, v68 offset:3344
  ds_write_b32 v13, v69 offset:3348
  ds_write_b32 v13, v70 offset:3352
  ds_write_b32 v13, v71 offset:3356
  ds_write_b32 v13, v72 offset:3360
  s_waitcnt lgkmcnt(0)
  ds_read_b128 v[120:123], v15 offset:3328
  ds_read_b128 v[124:127], v15 offset:3392
  ds_read_b128 v[128:131], v15 offset:3456
  ds_read_b128 v[132:135], v15 offset:3520
  ds_read_b128 v[136:139], v15 offset:3584
  ds_read_b128 v[140:143], v15 offset:3648
  ds_read_b128 v[144:147], v15 offset:3712
  ds_read_b128 v[148:151], v15 offset:3776
  ds_read_b128 v[152:155], v15 offset:3840
  s_waitcnt lgkmcnt(0)
  ds_read_b128 v[156:159], v15 offset:3904
  ds_read_b128 v[160:163], v15 offset:3968
  ds_read_b128 v[164:167], v15 offset:4032
  ds_read_b128 v[168:171], v15 offset:4096
  ds_read_b128 v[172:175], v15 offset:4160
  ds_read_b128 v[176:179], v15 offset:4224
  ds_read_b128 v[180:183], v15 offset:4288
  ds_read_b128 v[184:187], v15 offset:4352
  ds_read_b128 v[188:191], v15 offset:4416
  s_waitcnt vmcnt(0)
  s_mov_b64 exec, 1
  ds_add_u32 v12, v18 offset:520
  s_mov_b64 exec, -1
L_h_sync:
  ds_read_b32 v18, v12 offset:520
  s_waitcnt lgkmcnt(0)
  v_readfirstlane_b32 s64, v18
  s_nop 0
  s_cmp_lt_u32 s64, 4
  s_cbranch_scc1 L_h_sync
  ds_read_b64_tr_b16 v[192:193], v16 offset:14336
  ds_read_b64_tr_b16 v[194:195], v16 offset:14848
  ds_read_b64_tr_b16 v[196:197], v16 offset:18432
  ds_read_b64_tr_b16 v[198:199], v16 offset:18944
  ds_read_b64_tr_b16 v[200:201], v16 offset:22528
  ds_read_b64_tr_b16 v[202:203], v16 offset:23040
  ds_read_b64_tr_b16 v[204:205], v16 offset:26624
  ds_read_b64_tr_b16 v[206:207], v16 offset:27136
  ds_read_b64_tr_b16 v[208:209], v16 offset:30720
  ds_read_b64_tr_b16 v[210:211], v16 offset:31232
  ds_read_b64_tr_b16 v[212:213], v20 offset:2048
  ds_read_b64_tr_b16 v[214:215], v20 offset:2560
  s_waitcnt lgkmcnt(10)
  v_mfma_f32_16x16x32_bf16 v[76:79], v[120:123], v[192:195], 0
  s_waitcnt lgkmcnt(8)
  v_mfma_f32_16x16x32_bf16 v[76:79], v[124:127], v[196:199], v[76:79]
  s_waitcnt lgkmcnt(6)
  v_mfma_f32_16x16x32_bf16 v[76:79], v[128:131], v[200:203], v[76:79]
  s_waitcnt lgkmcnt(4)
  v_mfma_f32_16x16x32_bf16 v[76:79], v[132:135], v[204:207], v[76:79]
  s_waitcnt lgkmcnt(2)
  v_mfma_f32_16x16x32_bf16 v[76:79], v[136:139], v[208:211], v[76:79]
  s_waitcnt lgkmcnt(0)
  v_mfma_f32_16x16x32_bf16 v[76:79], v[140:143], v[212:215], v[76:79]
  ds_read_b64_tr_b16 v[216:217], v20 offset:6144
  ds_read_b64_tr_b16 v[218:219], v20 offset:6656
  ds_read_b64_tr_b16 v[220:221], v20 offset:10240
  ds_read_b64_tr_b16 v[222:223], v20 offset:10752
  ds_read_b64_tr_b16 v[224:225], v20 offset:14336
  ds_read_b64_tr_b16 v[226:227], v20 offset:14848
  ds_read_b64_tr_b16 v[228:229], v20 offset:18432
  ds_read_b64_tr_b16 v[230:231], v20 offset:18944
  ds_read_b64_tr_b16 v[232:233], v20 offset:22528
  ds_read_b64_tr_b16 v[234:235], v20 offset:23040
  ds_read_b64_tr_b16 v[236:237], v20 offset:26624
  ds_read_b64_tr_b16 v[238:239], v20 offset:27136
  s_waitcnt lgkmcnt(10)
  v_mfma_f32_16x16x32_bf16 v[76:79], v[144:147], v[216:219], v[76:79]
  s_waitcnt lgkmcnt(8)
  v_mfma_f32_16x16x32_bf16 v[76:79], v[148:151], v[220:223], v[76:79]
  s_waitcnt lgkmcnt(6)
  v_mfma_f32_16x16x32_bf16 v[76:79], v[152:155], v[224:227], v[76:79]
  s_waitcnt lgkmcnt(4)
  v_mfma_f32_16x16x32_bf16 v[76:79], v[156:159], v[228:231], v[76:79]
  s_waitcnt lgkmcnt(2)
  v_mfma_f32_16x16x32_bf16 v[76:79], v[160:163], v[232:235], v[76:79]
  s_waitcnt lgkmcnt(0)
  v_mfma_f32_16x16x32_bf16 v[76:79], v[164:167], v[236:239], v[76:79]
  ds_read_b64_tr_b16 v[192:193], v20 offset:30720
  ds_read_b64_tr_b16 v[194:195], v20 offset:31232
  ds_read_b64_tr_b16 v[196:197], v20 offset:34816
  ds_read_b64_tr_b16 v[198:199], v20 offset:35328
  ds_read_b64_tr_b16 v[200:201], v20 offset:38912
  ds_read_b64_tr_b16 v[202:203], v20 offset:39424
  ds_read_b64_tr_b16 v[204:205], v20 offset:43008
  ds_read_b64_tr_b16 v[206:207], v20 offset:43520
  ds_read_b64_tr_b16 v[208:209], v20 offset:47104
  ds_read_b64_tr_b16 v[210:211], v20 offset:47616
  ds_read_b64_tr_b16 v[212:213], v20 offset:51200
  ds_read_b64_tr_b16 v[214:215], v20 offset:51712
  s_waitcnt lgkmcnt(10)
  v_mfma_f32_16x16x32_bf16 v[76:79], v[168:171], v[192:195], v[76:79]
  s_waitcnt lgkmcnt(8)
  v_mfma_f32_16x16x32_bf16 v[76:79], v[172:175], v[196:199], v[76:79]
  s_waitcnt lgkmcnt(6)
  v_mfma_f32_16x16x32_bf16 v[76:79], v[176:179], v[200:203], v[76:79]
  s_waitcnt lgkmcnt(4)
  v_mfma_f32_16x16x32_bf16 v[76:79], v[180:183], v[204:207], v[76:79]
  s_waitcnt lgkmcnt(2)
  v_mfma_f32_16x16x32_bf16 v[76:79], v[184:187], v[208:211], v[76:79]
  s_waitcnt lgkmcnt(0)
  v_mfma_f32_16x16x32_bf16 v[76:79], v[188:191], v[212:215], v[76:79]
  v_mov_b32 v18, 1
  s_mov_b64 exec, 1
  ds_add_u32 v12, v18 offset:556
  s_mov_b64 exec, -1
  s_add_u32 s64, s78, 1
  s_add_u32 s65, s79, 1
  v_cmp_eq_u32 vcc, 1, v3
  v_mov_b32 v19, s64
  v_mov_b32 v21, s65
  s_nop 3
  v_cndmask_b32 v19, v19, v21, vcc
  v_cndmask_b32 v18, v76, v77, vcc
  s_nop 1
  v_mov_b32_dpp v21, v18 quad_perm:[1,0,3,2] row_mask:0xf bank_mask:0xf
  v_cvt_pk_bf16_f32 v18, v18, v21
  s_mov_b64 exec, 0x55555555
  buffer_store_dwordx2 v[18:19], v17, s[48:51], s39 offen sc1
  s_mov_b64 exec, -1
  s_branch L_h_q
L_h_ln2:
  v_lshlrev_b32 v80, 16, v64
  v_and_b32 v81, 0xffff0000, v64
  v_lshlrev_b32 v82, 16, v65
  v_and_b32 v83, 0xffff0000, v65
  v_lshlrev_b32 v84, 16, v66
  v_and_b32 v85, 0xffff0000, v66
  v_lshlrev_b32 v86, 16, v67
  v_and_b32 v87, 0xffff0000, v67
  v_lshlrev_b32 v88, 16, v68
  v_and_b32 v89, 0xffff0000, v68
  v_lshlrev_b32 v90, 16, v69
  v_and_b32 v91, 0xffff0000, v69
  v_lshlrev_b32 v92, 16, v70
  v_and_b32 v93, 0xffff0000, v70
  v_lshlrev_b32 v94, 16, v71
  v_and_b32 v95, 0xffff0000, v71
  v_lshlrev_b32 v96, 16, v72
  v_and_b32 v97, 0xffff0000, v72
  v_add_f32 v116, v80, v81
  v_add_f32 v117, v82, v83
  v_add_f32 v116, v116, v84
  v_add_f32 v117, v117, v85
  v_add_f32 v116, v116, v86
  v_add_f32 v117, v117, v87
  v_add_f32 v116, v116, v88
  v_add_f32 v117, v117, v89
  v_add_f32 v116, v116, v90
  v_add_f32 v117, v117, v91
  v_add_f32 v116, v116, v92
  v_add_f32 v117, v117, v93
  v_add_f32 v116, v116, v94
  v_add_f32 v117, v117, v95
  v_add_f32 v116, v116, v96
  v_add_f32 v117, v117, v97
  v_add_f32 v116, v116, v117
  s_nop 1
  v_add_f32_dpp v116, v116, v116 quad_perm:[1,0,3,2] row_mask:0xf bank_mask:0xf
  s_nop 1
  v_add_f32_dpp v116, v116, v116 quad_perm:[2,3,0,1] row_mask:0xf bank_mask:0xf
  s_nop 1
  v_add_f32_dpp v116, v116, v116 row_half_mirror row_mask:0xf bank_mask:0xf
  s_nop 1
  v_add_f32_dpp v116, v116, v116 row_mirror row_mask:0xf bank_mask:0xf
  v_mov_b32 v117, v116
  s_nop 1
  v_permlane16_swap_b32 v116, v117
  v_add_f32 v116, v116, v117
  v_mul_f32 v116, 0x3ae38e39, v116
  v_sub_f32 v98, v80, v116
  v_sub_f32 v99, v81, v116
  v_sub_f32 v100, v82, v116
  v_sub_f32 v101, v83, v116
  v_sub_f32 v102, v84, v116
  v_sub_f32 v103, v85, v116
  v_sub_f32 v104, v86, v116
  v_sub_f32 v105, v87, v116
  v_sub_f32 v106, v88, v116
  v_sub_f32 v107, v89, v116
  v_sub_f32 v108, v90, v116
  v_sub_f32 v109, v91, v116
  v_sub_f32 v110, v92, v116
  v_sub_f32 v111, v93, v116
  v_sub_f32 v112, v94, v116
  v_sub_f32 v113, v95, v116
  v_sub_f32 v114, v96, v116
  v_sub_f32 v115, v97, v116
  v_mul_f32 v117, v98, v98
  v_mul_f32 v118, v99, v99
  v_fmac_f32 v117, v100, v100
  v_fmac_f32 v118, v101, v101
  v_fmac_f32 v117, v102, v102
  v_fmac_f32 v118, v103, v103
  v_fmac_f32 v117, v104, v104
  v_fmac_f32 v118, v105, v105
  v_fmac_f32 v117, v106, v106
  v_fmac_f32 v118, v107, v107
  v_fmac_f32 v117, v108, v108
  v_fmac_f32 v118, v109, v109
  v_fmac_f32 v117, v110, v110
  v_fmac_f32 v118, v111, v111
  v_fmac_f32 v117, v112, v112
  v_fmac_f32 v118, v113, v113
  v_fmac_f32 v117, v114, v114
  v_fmac_f32 v118, v115, v115
  v_add_f32 v117, v117, v118
  v_cvt_pk_bf16_f32 v116, 0, v116
  s_nop 1
  v_add_f32_dpp v117, v117, v117 quad_perm:[1,0,3,2] row_mask:0xf bank_mask:0xf
  s_nop 1
  v_add_f32_dpp v117, v117, v117 quad_perm:[2,3,0,1] row_mask:0xf bank_mask:0xf
  s_nop 1
  v_add_f32_dpp v117, v117, v117 row_half_mirror row_mask:0xf bank_mask:0xf
  s_nop 1
  v_add_f32_dpp v117, v117, v117 row_mirror row_mask:0xf bank_mask:0xf
  v_mov_b32 v118, v117
  s_nop 1
  v_permlane16_swap_b32 v117, v118
  v_add_f32 v117, v117, v118
  v_mul_f32 v117, 0x3ae38e39, v117
  v_cvt_pk_bf16_f32 v117, 0, v117
  v_add_f32 v117, 0x3727c5ac, v117
  v_cvt_pk_bf16_f32 v117, 0, v117
  v_sqrt_f32 v117, v117
  v_sub_f32 v98, v80, v116
  v_cvt_pk_bf16_f32 v117, 0, v117
  v_rcp_f32 v117, v117
  v_sub_f32 v99, v81, v116
  v_sub_f32 v100, v82, v116
  v_sub_f32 v101, v83, v116
  v_sub_f32 v102, v84, v116
  v_sub_f32 v103, v85, v116
  v_sub_f32 v104, v86, v116
  v_sub_f32 v105, v87, v116
  v_sub_f32 v106, v88, v116
  v_sub_f32 v107, v89, v116
  v_sub_f32 v108, v90, v116
  v_sub_f32 v109, v91, v116
  v_sub_f32 v110, v92, v116
  v_sub_f32 v111, v93, v116
  v_sub_f32 v112, v94, v116
  v_sub_f32 v113, v95, v116
  v_sub_f32 v114, v96, v116
  v_sub_f32 v115, v97, v116
  v_cvt_pk_bf16_f32 v98, 0, v98
  v_cvt_pk_bf16_f32 v99, 0, v99
  v_cvt_pk_bf16_f32 v100, 0, v100
  v_cvt_pk_bf16_f32 v101, 0, v101
  v_cvt_pk_bf16_f32 v102, 0, v102
  v_cvt_pk_bf16_f32 v103, 0, v103
  v_cvt_pk_bf16_f32 v104, 0, v104
  v_cvt_pk_bf16_f32 v105, 0, v105
  v_cvt_pk_bf16_f32 v106, 0, v106
  v_cvt_pk_bf16_f32 v107, 0, v107
  v_cvt_pk_bf16_f32 v108, 0, v108
  v_cvt_pk_bf16_f32 v109, 0, v109
  v_cvt_pk_bf16_f32 v110, 0, v110
  v_cvt_pk_bf16_f32 v111, 0, v111
  v_cvt_pk_bf16_f32 v112, 0, v112
  v_cvt_pk_bf16_f32 v113, 0, v113
  v_cvt_pk_bf16_f32 v114, 0, v114
  v_cvt_pk_bf16_f32 v115, 0, v115
  v_mul_f32 v98, v98, v117
  v_mul_f32 v99, v99, v117
  v_mul_f32 v100, v100, v117
  v_mul_f32 v101, v101, v117
  v_mul_f32 v102, v102, v117
  v_mul_f32 v103, v103, v117
  v_mul_f32 v104, v104, v117
  v_mul_f32 v105, v105, v117
  v_mul_f32 v106, v106, v117
  v_mul_f32 v107, v107, v117
  v_mul_f32 v108, v108, v117
  v_mul_f32 v109, v109, v117
  v_mul_f32 v110, v110, v117
  v_mul_f32 v111, v111, v117
  v_mul_f32 v112, v112, v117
  v_mul_f32 v113, v113, v117
  v_mul_f32 v114, v114, v117
  v_mul_f32 v115, v115, v117
  v_cvt_pk_bf16_f32 v64, v98, v99
  v_cvt_pk_bf16_f32 v65, v100, v101
  v_cvt_pk_bf16_f32 v66, v102, v103
  v_cvt_pk_bf16_f32 v67, v104, v105
  v_cvt_pk_bf16_f32 v68, v106, v107
  v_cvt_pk_bf16_f32 v69, v108, v109
  v_cvt_pk_bf16_f32 v70, v110, v111
  v_cvt_pk_bf16_f32 v71, v112, v113
  v_cvt_pk_bf16_f32 v72, v114, v115
  ds_write_b32 v13, v64 offset:5632
  ds_write_b32 v13, v65 offset:5636
  ds_write_b32 v13, v66 offset:5640
  ds_write_b32 v13, v67 offset:5644
  ds_write_b32 v13, v68 offset:5648
  ds_write_b32 v13, v69 offset:5652
  ds_write_b32 v13, v70 offset:5656
  ds_write_b32 v13, v71 offset:5660
  ds_write_b32 v13, v72 offset:5664
  ds_write_b32 v12, v18 offset:524
  s_branch L_h_join
L_h_noln:
L_h_q:
  s_cmp_eq_u32 s30, 1
  s_cbranch_scc0 L_h_join
  s_lshl_b32 s39, s31, 10
  s_add_u32 s39, s39, 942080
  v_lshlrev_b32 v22, 3, v1
  s_waitcnt lgkmcnt(0)
  s_cmp_eq_u32 s33, 0
  s_cselect_b32 s79, s78, s79
  s_add_u32 s79, s79, 1
  s_mov_b32 s70, 200000
L_go:
  ds_read_b32 v14, v12 offset:552
  s_waitcnt lgkmcnt(0)
  v_readfirstlane_b32 s64, v14
  s_nop 0
  s_cmp_eq_u32 s64, 0
  s_cbranch_scc0 L_go_ok
  s_sleep 4
  s_branch L_go
L_go_ok:
L_qp:
  buffer_load_dwordx4 v[64:67], v11, s[48:51], s39 offen sc1
  s_waitcnt vmcnt(0)
  v_xor_b32 v14, s79, v65
  v_xor_b32 v15, s79, v67
  v_mov_b32 v16, v64
  v_or_b32 v14, v14, v15
  v_mov_b32 v17, v66
  v_cmp_ne_u32 vcc, 0, v14
  s_cbranch_vccz L_qp_done
  s_mov_b64 exec, vcc
  s_sub_u32 s70, s70, 1
  s_cmp_lg_u32 s70, 0
  s_cbranch_scc1 L_qp
L_qp_done:
  s_mov_b64 exec, -1
  ds_write_b64 v22, v[16:17] offset:0
  v_mov_b32 v14, 1
  v_mov_b32 v15, s79
  ds_write_b64 v12, v[14:15] offset:512
L_h_join:
  v_and_b32 v4, 7, v2
  v_lshrrev_b32 v5, 1, v4
  v_and_b32 v6, 1, v4
  v_mov_b32 v7, 0x0c0c0100
  v_mov_b32 v8, 0x01000c0c
  v_cmp_eq_u32 vcc, 1, v6
  v_mov_b32 v9, 0x0c0c0302
  v_mov_b32 v10, 0x03020c0c
  v_cndmask_b32 v7, v7, v8, vcc
  v_cndmask_b32 v9, v9, v10, vcc
  v_mov_b32 v8, 0x0c0c0c0c
  v_cmp_eq_u32 vcc, 0, v5
  s_nop 1
  v_cndmask_b32 v40, v8, v7, vcc
  v_cndmask_b32 v44, v8, v9, vcc
  v_cmp_eq_u32 vcc, 1, v5
  s_nop 1
  v_cndmask_b32 v41, v8, v7, vcc
  v_cndmask_b32 v45, v8, v9, vcc
  v_cmp_eq_u32 vcc, 2, v5
  s_nop 1
  v_cndmask_b32 v42, v8, v7, vcc
  v_cndmask_b32 v46, v8, v9, vcc
  v_cmp_eq_u32 vcc, 3, v5
  s_nop 1
  v_cndmask_b32 v43, v8, v7, vcc
  v_cndmask_b32 v47, v8, v9, vcc
  v_lshrrev_b32 v5, 3, v2
  v_lshl_add_u32 v5, v5, 2, v3
  v_and_b32 v7, 7, v2
  s_mul_i32 s74, s31, 10240
  s_lshr_b32 s64, s32, 2
  s_lshl_b32 s64, s64, 4
  s_add_u32 s69, s74, s64
  s_lshl_b32 s64, s32, 7
  s_add_u32 s74, s74, s64
L_h_qf:
  ds_read_b32 v14, v12 offset:512
  s_waitcnt lgkmcnt(0)
  v_readfirstlane_b32 s64, v14
  s_nop 0
  s_cmp_eq_u32 s64, 0
  s_cbranch_scc0 L_h_qf_ok
  s_sleep 8
  s_branch L_h_qf
L_h_qf_ok:
  ds_read_b32 v14, v12 offset:516
  s_waitcnt lgkmcnt(0)
  v_readfirstlane_b32 s79, v14
  s_mul_i32 s64, s31, 768
  s_add_u32 s36, s64, 917504
  s_add_u32 s60, s28, s36
  s_addc_u32 s61, s29, 0
  s_lshl_b32 s64, s32, 2
  s_add_u32 s64, s64, s30
  s_cmp_lg_u32 s64, 3
  s_cbranch_scc1 L_nopool
  s_and_b32 s64, s31, 3
  s_lshl_b32 s64, s64, 3
  s_lshl_b32 s64, 12, s64
  s_sub_u32 s64, 2021161080, s64
  v_mov_b32 v14, s64
  v_mov_b32 v15, s64
  v_mov_b32 v16, s79
  s_mov_b64 exec, 1
  buffer_store_dwordx2 v[14:15], v12, s[48:51], s36 offen sc1
  s_waitcnt vmcnt(0)
  buffer_store_dword v16, v12, s[48:51], s36 offen offset:128 sc1
  s_mov_b64 exec, -1
L_nopool:
  s_mov_b32 s52, s12
  s_mov_b32 s53, s13
  s_mov_b32 s54, 4718592
  s_mov_b32 s55, 0x20000
  v_mul_u32_u24 v30, 1152, v5
  v_lshl_add_u32 v30, v7, 4, v30
  s_mul_i32 s64, s35, 36864
  s_add_u32 s64, s64, 0
  s_lshl_b32 s65, s30, 8
  s_add_u32 s65, s65, s64
  buffer_load_dwordx4 v[104:107], v30, s[52:55], s65 offen offset:0 nt
  buffer_load_dwordx4 v[120:123], v30, s[52:55], s65 offen offset:128 nt
  s_add_u32 s65, s65, 9216
  s_waitcnt vmcnt(1)
  buffer_load_dwordx4 v[108:111], v30, s[52:55], s65 offen offset:0 nt
  s_waitcnt vmcnt(1)
  buffer_load_dwordx4 v[124:127], v30, s[52:55], s65 offen offset:128 nt
  s_add_u32 s65, s65, 9216
  s_waitcnt vmcnt(1)
  buffer_load_dwordx4 v[112:115], v30, s[52:55], s65 offen offset:0 nt
  s_waitcnt vmcnt(1)
  buffer_load_dwordx4 v[128:131], v30, s[52:55], s65 offen offset:128 nt
  s_add_u32 s65, s65, 9216
  s_waitcnt vmcnt(1)
  buffer_load_dwordx4 v[116:119], v30, s[52:55], s65 offen offset:0 nt
  s_waitcnt vmcnt(1)
  buffer_load_dwordx4 v[132:135], v30, s[52:55], s65 offen offset:128 nt
  s_cmp_lg_u32 s30, 3
  s_cbranch_scc1 L_nowo8a
  s_waitcnt vmcnt(1)
  buffer_load_dwordx4 v[136:139], v30, s[52:55], s64 offen offset:1024 nt
  s_add_u32 s64, s64, 9216
  s_waitcnt vmcnt(1)
  buffer_load_dwordx4 v[140:143], v30, s[52:55], s64 offen offset:1024 nt
  s_add_u32 s64, s64, 9216
  s_waitcnt vmcnt(1)
  buffer_load_dwordx4 v[144:147], v30, s[52:55], s64 offen offset:1024 nt
  s_add_u32 s64, s64, 9216
  s_waitcnt vmcnt(1)
  buffer_load_dwordx4 v[148:151], v30, s[52:55], s64 offen offset:1024 nt
L_nowo8a:
  s_lshl_b32 s80, s73, 5
  s_mul_i32 s64, s33, 576
  s_add_u32 s80, s80, s64
  v_and_b32 v17, 1, v3
  v_lshrrev_b32 v18, 1, v3
  v_lshl_add_u32 v17, v17, 1, v18
  v_lshl_add_u32 v17, v17, 3, v7
  v_lshlrev_b32 v24, 2, v17
  v_add_u32 v17, s80, v17
  v_lshlrev_b32 v25, 1, v17
  s_cmp_lg_u32 s3, 2
  s_cbranch_scc1 L_nob
  s_mul_i32 s64, s30, 2304
  v_add_u32 v15, s64, v11
  v_add_u32 v16, s64, v23
  s_waitcnt vmcnt(1)
  global_load_dwordx4 v[64:67], v15, s[16:17]
  s_waitcnt vmcnt(1)
  global_load_dwordx4 v[68:71], v15, s[16:17] offset:1024
  s_waitcnt vmcnt(1)
  global_load_dword v72, v16, s[16:17] offset:2048
  s_waitcnt vmcnt(1)
  global_load_dwordx4 v[76:79], v15, s[18:19]
  s_waitcnt vmcnt(1)
  global_load_dwordx4 v[80:83], v15, s[18:19] offset:1024
  s_waitcnt vmcnt(1)
  global_load_dword v84, v16, s[18:19] offset:2048
  s_waitcnt vmcnt(1)
  global_load_dwordx4 v[88:91], v15, s[20:21]
  s_waitcnt vmcnt(1)
  global_load_dwordx4 v[92:95], v15, s[20:21] offset:1024
  s_waitcnt vmcnt(1)
  global_load_dword v96, v16, s[20:21] offset:2048
  s_waitcnt vmcnt(1)
  buffer_load_ushort v26, v25, s[40:43], 0 offen
  s_waitcnt vmcnt(1)
  global_load_ushort v27, v12, s[22:23]
L_h_hf:
  ds_read_b32 v14, v12 offset:524
  s_waitcnt lgkmcnt(0)
  v_readfirstlane_b32 s64, v14
  s_nop 0
  s_cmp_eq_u32 s64, 0
  s_cbranch_scc0 L_h_hf_ok
  s_sleep 8
  s_branch L_h_hf
L_h_hf_ok:
  s_mov_b32 s66, 0xbdd2d3e8
  v_mov_b32 v17, 0xc0135761
  s_lshl_b32 s64, s80, 1
  s_add_u32 s64, s64, 5632
  v_mov_b32 v18, s64
  s_lshl_b32 s64, s30, 7
  s_add_u32 s64, s64, 1280
  v_mov_b32 v19, s64
  s_waitcnt vmcnt(0)
  v_lshlrev_b32 v152, 16, v64
  v_and_b32 v153, 0xffff0000, v64
  v_lshlrev_b32 v154, 16, v65
  v_and_b32 v155, 0xffff0000, v65
  v_lshlrev_b32 v156, 16, v66
  v_and_b32 v157, 0xffff0000, v66
  v_lshlrev_b32 v158, 16, v67
  v_and_b32 v159, 0xffff0000, v67
  v_lshlrev_b32 v160, 16, v68
  v_and_b32 v161, 0xffff0000, v68
  v_lshlrev_b32 v162, 16, v69
  v_and_b32 v163, 0xffff0000, v69
  v_lshlrev_b32 v164, 16, v70
  v_and_b32 v165, 0xffff0000, v70
  v_lshlrev_b32 v166, 16, v71
  v_and_b32 v167, 0xffff0000, v71
  v_lshlrev_b32 v168, 16, v72
  v_and_b32 v169, 0xffff0000, v72
  v_lshlrev_b32 v170, 16, v76
  v_and_b32 v171, 0xffff0000, v76
  v_lshlrev_b32 v172, 16, v77
  v_and_b32 v173, 0xffff0000, v77
  v_lshlrev_b32 v174, 16, v78
  v_and_b32 v175, 0xffff0000, v78
  v_lshlrev_b32 v176, 16, v79
  v_and_b32 v177, 0xffff0000, v79
  v_lshlrev_b32 v178, 16, v80
  v_and_b32 v179, 0xffff0000, v80
  v_lshlrev_b32 v180, 16, v81
  v_and_b32 v181, 0xffff0000, v81
  v_lshlrev_b32 v182, 16, v82
  v_and_b32 v183, 0xffff0000, v82
  v_lshlrev_b32 v184, 16, v83
  v_and_b32 v185, 0xffff0000, v83
  v_lshlrev_b32 v186, 16, v84
  v_and_b32 v187, 0xffff0000, v84
  v_lshlrev_b32 v188, 16, v88
  v_and_b32 v189, 0xffff0000, v88
  v_lshlrev_b32 v190, 16, v89
  v_and_b32 v191, 0xffff0000, v89
  v_lshlrev_b32 v192, 16, v90
  v_and_b32 v193, 0xffff0000, v90
  v_lshlrev_b32 v194, 16, v91
  v_and_b32 v195, 0xffff0000, v91
  v_lshlrev_b32 v196, 16, v92
  v_and_b32 v197, 0xffff0000, v92
  v_lshlrev_b32 v198, 16, v93
  v_and_b32 v199, 0xffff0000, v93
  v_lshlrev_b32 v200, 16, v94
  v_and_b32 v201, 0xffff0000, v94
  v_lshlrev_b32 v202, 16, v95
  v_and_b32 v203, 0xffff0000, v95
  v_lshlrev_b32 v204, 16, v96
  v_and_b32 v205, 0xffff0000, v96
  s_mov_b32 s70, 0
  s_setprio 0
L_bloop:
  ds_read_u16 v20, v18
  v_add_u32 v18, 2, v18
  s_waitcnt lgkmcnt(0)
  v_lshlrev_b32 v20, 16, v20
  v_mul_f32 v206, v20, v152
  v_mul_f32 v207, v20, v153
  v_mul_f32 v208, v20, v154
  v_mul_f32 v209, v20, v155
  v_mul_f32 v210, v20, v156
  v_mul_f32 v211, v20, v157
  v_mul_f32 v212, v20, v158
  v_mul_f32 v213, v20, v159
  v_mul_f32 v214, v20, v160
  v_mul_f32 v215, v20, v161
  v_mul_f32 v216, v20, v162
  v_mul_f32 v217, v20, v163
  v_mul_f32 v218, v20, v164
  v_mul_f32 v219, v20, v165
  v_mul_f32 v220, v20, v166
  v_mul_f32 v221, v20, v167
  v_mul_f32 v222, v20, v168
  v_mul_f32 v223, v20, v169
  v_cvt_pk_bf16_f32 v206, 0, v206
  v_cvt_pk_bf16_f32 v207, 0, v207
  v_cvt_pk_bf16_f32 v208, 0, v208
  v_cvt_pk_bf16_f32 v209, 0, v209
  v_cvt_pk_bf16_f32 v210, 0, v210
  v_cvt_pk_bf16_f32 v211, 0, v211
  v_cvt_pk_bf16_f32 v212, 0, v212
  v_cvt_pk_bf16_f32 v213, 0, v213
  v_cvt_pk_bf16_f32 v214, 0, v214
  v_cvt_pk_bf16_f32 v215, 0, v215
  v_cvt_pk_bf16_f32 v216, 0, v216
  v_cvt_pk_bf16_f32 v217, 0, v217
  v_cvt_pk_bf16_f32 v218, 0, v218
  v_cvt_pk_bf16_f32 v219, 0, v219
  v_cvt_pk_bf16_f32 v220, 0, v220
  v_cvt_pk_bf16_f32 v221, 0, v221
  v_cvt_pk_bf16_f32 v222, 0, v222
  v_cvt_pk_bf16_f32 v223, 0, v223
  v_add_f32 v206, v206, v170
  v_add_f32 v207, v207, v171
  v_add_f32 v208, v208, v172
  v_add_f32 v209, v209, v173
  v_add_f32 v210, v210, v174
  v_add_f32 v211, v211, v175
  v_add_f32 v212, v212, v176
  v_add_f32 v213, v213, v177
  v_add_f32 v214, v214, v178
  v_add_f32 v215, v215, v179
  v_add_f32 v216, v216, v180
  v_add_f32 v217, v217, v181
  v_add_f32 v218, v218, v182
  v_add_f32 v219, v219, v183
  v_add_f32 v220, v220, v184
  v_add_f32 v221, v221, v185
  v_add_f32 v222, v222, v186
  v_add_f32 v223, v223, v187
  v_cvt_pk_bf16_f32 v206, 0, v206
  v_cvt_pk_bf16_f32 v207, 0, v207
  v_cvt_pk_bf16_f32 v208, 0, v208
  v_cvt_pk_bf16_f32 v209, 0, v209
  v_cvt_pk_bf16_f32 v210, 0, v210
  v_cvt_pk_bf16_f32 v211, 0, v211
  v_cvt_pk_bf16_f32 v212, 0, v212
  v_cvt_pk_bf16_f32 v213, 0, v213
  v_cvt_pk_bf16_f32 v214, 0, v214
  v_cvt_pk_bf16_f32 v215, 0, v215
  v_cvt_pk_bf16_f32 v216, 0, v216
  v_cvt_pk_bf16_f32 v217, 0, v217
  v_cvt_pk_bf16_f32 v218, 0, v218
  v_cvt_pk_bf16_f32 v219, 0, v219
  v_cvt_pk_bf16_f32 v220, 0, v220
  v_cvt_pk_bf16_f32 v221, 0, v221
  v_cvt_pk_bf16_f32 v222, 0, v222
  v_cvt_pk_bf16_f32 v223, 0, v223
  v_mul_f32 v224, v206, v206
  v_mul_f32 v225, v207, v207
  v_mul_f32 v226, v208, v208
  v_mul_f32 v227, v209, v209
  v_mul_f32 v228, v210, v210
  v_mul_f32 v229, v211, v211
  v_mul_f32 v230, v212, v212
  v_mul_f32 v231, v213, v213
  v_mul_f32 v232, v214, v214
  v_mul_f32 v233, v215, v215
  v_mul_f32 v234, v216, v216
  v_mul_f32 v235, v217, v217
  v_mul_f32 v236, v218, v218
  v_mul_f32 v237, v219, v219
  v_mul_f32 v238, v220, v220
  v_mul_f32 v239, v221, v221
  v_mul_f32 v240, v222, v222
  v_mul_f32 v241, v223, v223
  v_fma_f32 v224, v224, s66, v17
  v_fma_f32 v225, v225, s66, v17
  v_fma_f32 v226, v226, s66, v17
  v_fma_f32 v227, v227, s66, v17
  v_fma_f32 v228, v228, s66, v17
  v_fma_f32 v229, v229, s66, v17
  v_fma_f32 v230, v230, s66, v17
  v_fma_f32 v231, v231, s66, v17
  v_fma_f32 v232, v232, s66, v17
  v_fma_f32 v233, v233, s66, v17
  v_fma_f32 v234, v234, s66, v17
  v_fma_f32 v235, v235, s66, v17
  v_fma_f32 v236, v236, s66, v17
  v_fma_f32 v237, v237, s66, v17
  v_fma_f32 v238, v238, s66, v17
  v_fma_f32 v239, v239, s66, v17
  v_fma_f32 v240, v240, s66, v17
  v_fma_f32 v241, v241, s66, v17
  v_mul_f32 v224, v224, v206
  v_mul_f32 v225, v225, v207
  v_mul_f32 v226, v226, v208
  v_mul_f32 v227, v227, v209
  v_mul_f32 v228, v228, v210
  v_mul_f32 v229, v229, v211
  v_mul_f32 v230, v230, v212
  v_mul_f32 v231, v231, v213
  v_mul_f32 v232, v232, v214
  v_mul_f32 v233, v233, v215
  v_mul_f32 v234, v234, v216
  v_mul_f32 v235, v235, v217
  v_mul_f32 v236, v236, v218
  v_mul_f32 v237, v237, v219
  v_mul_f32 v238, v238, v220
  v_mul_f32 v239, v239, v221
  v_mul_f32 v240, v240, v222
  v_mul_f32 v241, v241, v223
  v_exp_f32 v224, v224
  v_exp_f32 v225, v225
  v_exp_f32 v226, v226
  v_exp_f32 v227, v227
  v_exp_f32 v228, v228
  v_exp_f32 v229, v229
  v_exp_f32 v230, v230
  v_exp_f32 v231, v231
  v_exp_f32 v232, v232
  v_exp_f32 v233, v233
  v_exp_f32 v234, v234
  v_exp_f32 v235, v235
  v_exp_f32 v236, v236
  v_exp_f32 v237, v237
  v_exp_f32 v238, v238
  v_exp_f32 v239, v239
  v_exp_f32 v240, v240
  v_exp_f32 v241, v241
  v_add_f32 v224, 1.0, v224
  v_add_f32 v225, 1.0, v225
  v_add_f32 v226, 1.0, v226
  v_add_f32 v227, 1.0, v227
  v_add_f32 v228, 1.0, v228
  v_add_f32 v229, 1.0, v229
  v_add_f32 v230, 1.0, v230
  v_add_f32 v231, 1.0, v231
  v_add_f32 v232, 1.0, v232
  v_add_f32 v233, 1.0, v233
  v_add_f32 v234, 1.0, v234
  v_add_f32 v235, 1.0, v235
  v_add_f32 v236, 1.0, v236
  v_add_f32 v237, 1.0, v237
  v_add_f32 v238, 1.0, v238
  v_add_f32 v239, 1.0, v239
  v_add_f32 v240, 1.0, v240
  v_add_f32 v241, 1.0, v241
  v_rcp_f32 v224, v224
  v_rcp_f32 v225, v225
  v_rcp_f32 v226, v226
  v_rcp_f32 v227, v227
  v_rcp_f32 v228, v228
  v_rcp_f32 v229, v229
  v_rcp_f32 v230, v230
  v_rcp_f32 v231, v231
  v_rcp_f32 v232, v232
  v_rcp_f32 v233, v233
  v_rcp_f32 v234, v234
  v_rcp_f32 v235, v235
  v_rcp_f32 v236, v236
  v_rcp_f32 v237, v237
  v_rcp_f32 v238, v238
  v_rcp_f32 v239, v239
  v_rcp_f32 v240, v240
  v_rcp_f32 v241, v241
  v_mul_f32 v206, v206, v224
  v_mul_f32 v207, v207, v225
  v_mul_f32 v208, v208, v226
  v_mul_f32 v209, v209, v227
  v_mul_f32 v210, v210, v228
  v_mul_f32 v211, v211, v229
  v_mul_f32 v212, v212, v230
  v_mul_f32 v213, v213, v231
  v_mul_f32 v214, v214, v232
  v_mul_f32 v215, v215, v233
  v_mul_f32 v216, v216, v234
  v_mul_f32 v217, v217, v235
  v_mul_f32 v218, v218, v236
  v_mul_f32 v219, v219, v237
  v_mul_f32 v220, v220, v238
  v_mul_f32 v221, v221, v239
  v_mul_f32 v222, v222, v240
  v_mul_f32 v223, v223, v241
  v_cvt_pk_bf16_f32 v206, 0, v206
  v_cvt_pk_bf16_f32 v207, 0, v207
  v_cvt_pk_bf16_f32 v208, 0, v208
  v_cvt_pk_bf16_f32 v209, 0, v209
  v_cvt_pk_bf16_f32 v210, 0, v210
  v_cvt_pk_bf16_f32 v211, 0, v211
  v_cvt_pk_bf16_f32 v212, 0, v212
  v_cvt_pk_bf16_f32 v213, 0, v213
  v_cvt_pk_bf16_f32 v214, 0, v214
  v_cvt_pk_bf16_f32 v215, 0, v215
  v_cvt_pk_bf16_f32 v216, 0, v216
  v_cvt_pk_bf16_f32 v217, 0, v217
  v_cvt_pk_bf16_f32 v218, 0, v218
  v_cvt_pk_bf16_f32 v219, 0, v219
  v_cvt_pk_bf16_f32 v220, 0, v220
  v_cvt_pk_bf16_f32 v221, 0, v221
  v_cvt_pk_bf16_f32 v222, 0, v222
  v_cvt_pk_bf16_f32 v223, 0, v223
  v_mul_f32 v21, v206, v188
  v_mul_f32 v22, v207, v189
  v_fmac_f32 v21, v208, v190
  v_fmac_f32 v22, v209, v191
  v_fmac_f32 v21, v210, v192
  v_fmac_f32 v22, v211, v193
  v_fmac_f32 v21, v212, v194
  v_fmac_f32 v22, v213, v195
  v_fmac_f32 v21, v214, v196
  v_fmac_f32 v22, v215, v197
  v_fmac_f32 v21, v216, v198
  v_fmac_f32 v22, v217, v199
  v_fmac_f32 v21, v218, v200
  v_fmac_f32 v22, v219, v201
  v_fmac_f32 v21, v220, v202
  v_fmac_f32 v22, v221, v203
  v_fmac_f32 v21, v222, v204
  v_fmac_f32 v22, v223, v205
  v_add_f32 v21, v21, v22
  s_nop 1
  v_add_f32_dpp v21, v21, v21 quad_perm:[1,0,3,2] row_mask:0xf bank_mask:0xf
  s_nop 1
  v_add_f32_dpp v21, v21, v21 quad_perm:[2,3,0,1] row_mask:0xf bank_mask:0xf
  s_nop 1
  v_add_f32_dpp v21, v21, v21 row_half_mirror row_mask:0xf bank_mask:0xf
  s_nop 1
  v_add_f32_dpp v21, v21, v21 row_mirror row_mask:0xf bank_mask:0xf
  v_mov_b32 v22, v21
  s_nop 1
  v_permlane16_swap_b32 v21, v22
  v_add_f32 v21, v21, v22
  v_mov_b32 v22, v21
  s_nop 1
  v_permlane32_swap_b32 v21, v22
  v_add_f32 v21, v21, v22
  ds_write_b32 v19, v21
  v_add_u32 v19, 4, v19
  s_add_u32 s70, s70, 1
  s_cmp_lt_u32 s70, 32
  s_cbranch_scc1 L_bloop
  s_setprio 2
  v_mov_b32 v14, 1
  s_mov_b64 exec, 1
  ds_add_u32 v12, v14 offset:536
  s_mov_b64 exec, -1
L_h_bc:
  ds_read_b32 v14, v12 offset:536
  s_waitcnt lgkmcnt(0)
  v_readfirstlane_b32 s64, v14
  s_nop 0
  s_cmp_lt_u32 s64, 4
  s_cbranch_scc0 L_h_bc_ok
  s_sleep 8
  s_branch L_h_bc
L_h_bc_ok:
  ds_read_b32 v176, v24 offset:1280
  ds_read_b32 v177, v24 offset:1408
  ds_read_b32 v178, v24 offset:1536
  ds_read_b32 v179, v24 offset:1664
  s_waitcnt lgkmcnt(0)
  v_add_f32 v176, v176, v177
  v_add_f32 v178, v178, v179
  v_add_f32 v176, v176, v178
  v_lshlrev_b32 v26, 16, v26
  v_lshlrev_b32 v27, 16, v27
  v_cvt_pk_bf16_f32 v176, 0, v176
  v_add_f32 v27, v176, v27
  v_cvt_pk_bf16_f32 v27, 0, v27
L_nob:
  s_mov_b32 s56, s24
  s_mov_b32 s57, s25
  s_mov_b32 s58, 2304
  s_mov_b32 s59, 0x20000
  v_mul_u32_u24 v20, 1280, v7
  v_lshl_add_u32 v19, v5, 4, v20
  v_lshlrev_b32 v21, 4, v7
  v_lshl_add_u32 v21, v3, 7, v21
  v_lshlrev_b32 v22, 3, v1
  v_lshrrev_b32 v31, 3, v1
  v_mul_u32_u24 v31, 2304, v31
  v_lshl_add_u32 v31, v7, 4, v31
  s_mul_i32 s77, s2, 2304
  s_add_u32 s77, s77, 327680
  s_lshl_b32 s64, s30, 9
  s_add_u32 s76, s77, s64
  s_lshl_b32 s64, s33, 2
  s_add_u32 s64, s64, s30
  s_mul_i32 s81, s64, 73728
  s_lshl_b32 s64, s73, 7
  s_add_u32 s81, s81, s64
  s_add_u32 s81, s81, 327680
  s_add_u32 s82, s81, 18432
  s_add_u32 s46, s81, 36864
  s_add_u32 s47, s81, 55296
  s_and_b32 s78, s79, 0xff
  s_movk_i32 s75, 0xff
  v_mov_b32 v28, s78
  v_mov_b32 v29, 1
  s_cmp_lg_u32 s30, 3
  s_cbranch_scc1 L_nowarm1
  buffer_load_dwordx4 v[200:203], v19, s[48:51], s74 offen sc1
  buffer_load_dwordx4 v[204:207], v20, s[48:51], s69 offen offset:1024 sc1
L_nowarm1:
  s_cmp_lg_u32 s3, 2
  s_cbranch_scc1 L_nowarm2
  buffer_load_dwordx4 v[208:211], v31, s[48:51], s81 offen sc1
  buffer_load_dwordx4 v[212:215], v31, s[48:51], s82 offen sc1
  buffer_load_dwordx4 v[216:219], v31, s[48:51], s46 offen sc1
  buffer_load_dwordx4 v[220:223], v31, s[48:51], s47 offen sc1
L_nowarm2:
  s_cmp_lg_u32 s30, 2
  s_cbranch_scc1 L_nodisp
  v_lshlrev_b32 v16, 12, v1
  s_lshl_b32 s64, s32, 20
  s_add_u32 s64, s64, 999424
  s_cmp_eq_u32 s3, 1
  s_cselect_b32 s65, 49152, 0
  s_sub_u32 s64, s64, s65
  v_add_u32 v14, s64, v16
  s_mov_b64 exec, 15
  ds_write_b32 v23, v14 offset:576
  s_mov_b64 exec, -1
  s_mov_b32 s71, 4
  s_mov_b32 s83, 200000
L_prdy:
  buffer_load_dword v14, v12, s[48:51], s36 offen offset:128 sc1
  s_sub_u32 s83, s83, 1
  s_waitcnt vmcnt(0)
  v_readfirstlane_b32 s64, v14
  s_cmp_eq_u32 s83, 0
  s_cbranch_scc1 L_dend
  s_cmp_eq_u32 s64, s79
  s_cbranch_scc1 L_prdy_ok
  s_sleep 64
  s_branch L_prdy
L_prdy_ok:
  s_lshl_b32 s69, s32, 3
  s_mov_b32 s68, s69
  s_sub_u32 s70, 64, s69
  s_mov_b32 s62, 0x80808080
  s_mov_b32 s63, 0x80808080
  s_mov_b32 s37, 4
L_dw0:
  ds_read_b32 v14, v12 offset:528
  s_waitcnt lgkmcnt(0)
  v_readfirstlane_b32 s64, v14
  s_nop 0
  s_cmp_eq_u32 s64, 0
  s_cbranch_scc0 L_dw0_ok
  s_sleep 16
  s_branch L_dw0
L_dw0_ok:
L_dloop:
  s_sub_u32 s83, s71, 2
L_dw:
  ds_read_b32 v14, v12 offset:528
  s_waitcnt lgkmcnt(0)
  v_readfirstlane_b32 s64, v14
  s_nop 0
  s_cmp_lt_u32 s64, s83
  s_cbranch_scc0 L_dw_ok
  s_sleep 1
  s_branch L_dw
L_dw_ok:
L_drty:
  s_mov_b32 s38, s37
  s_mov_b32 s39, 0
  s_lshl_b64 s[38:39], s[38:39], s68
  s_mov_b64 s[66:67], s[38:39]
  s_atomic_add_x2 s[66:67], s[60:61], 0 glc
  s_lshl_b32 s83, s68, 17
  s_lshl_b32 s64, s71, 2
  v_add_u32 v15, s64, v23
  s_waitcnt lgkmcnt(0)
  s_lshr_b64 s[64:65], s[66:67], s68
  s_and_b32 s64, s64, 0xff
  s_cmp_ge_u32 s64, 128
  s_cbranch_scc1 L_dfail
  s_lshl_b32 s65, s64, 12
  s_add_u32 s65, s65, s83
  s_add_u32 s65, s65, 524288
  v_add_u32 v14, s65, v16
  s_sub_u32 s65, 128, s64
  s_min_u32 s65, s65, s37
  s_bfm_b64 exec, s65, 0
  ds_write_b32 v15, v14 offset:576
  s_mov_b64 exec, -1
  s_add_u32 s71, s71, s65
L_dfail:
  s_add_u32 s66, s38, s66
  s_addc_u32 s67, s39, s67
  s_andn2_b64 s[38:39], s[62:63], s[66:67]
  s_lshr_b64 s[44:45], s[38:39], s69
  s_lshl_b64 s[38:39], s[38:39], s70
  s_or_b64 s[38:39], s[38:39], s[44:45]
  s_cbranch_scc0 L_dend
  s_ff1_i32_b64 s65, s[38:39]
  s_add_u32 s65, s65, s69
  s_and_b32 s68, s65, 56
  s_lshr_b64 s[38:39], s[66:67], s68
  s_and_b32 s38, s38, 0xff
  s_cmp_lt_u32 s38, 116
  s_cselect_b32 s37, 4, 2
  s_cmp_ge_u32 s64, 128
  s_cbranch_scc1 L_drty
  s_cmp_lt_u32 s71, 160
  s_cbranch_scc1 L_dloop
L_dend:
  s_lshl_b32 s64, s71, 2
  v_add_u32 v15, s64, v23
  v_mov_b32 v14, 8388608
  s_mov_b64 exec, 15
  ds_write_b32 v15, v14 offset:576
  s_mov_b64 exec, -1
  v_mov_b32 v14, s71
  ds_write_b32 v12, v14 offset:532
L_nodisp:
  s_waitcnt vmcnt(0) lgkmcnt(0)
  s_mov_b32 s80, 200000
  s_barrier
  s_cmp_lg_u32 s30, 3
  s_cbranch_scc1 L_ow
L_reh:
  s_mov_b32 s70, s80
  buffer_load_dwordx4 v[200:203], v20, s[48:51], s69 offen offset:1024 sc1
  buffer_load_dwordx4 v[204:207], v19, s[48:51], s74 offen sc1
  s_sleep 6
L_p1:
  buffer_load_dwordx4 v[208:211], v20, s[48:51], s69 offen offset:1024 sc1
  buffer_load_dwordx4 v[212:215], v19, s[48:51], s74 offen sc1
  s_waitcnt vmcnt(2)
  v_xor_b32 v232, s78, v204
  v_xor_b32 v233, s78, v205
  v_xor_b32 v234, s78, v206
  v_xor_b32 v235, s78, v207
  v_xor_b32 v17, s79, v201
  v_xor_b32 v18, s79, v203
  v_or3_b32 v14, v232, v233, v234
  v_or_b32 v14, v14, v235
  v_mov_b32 v15, v200
  v_and_b32 v14, 0xff, v14
  v_or3_b32 v14, v14, v17, v18
  v_mov_b32 v16, v202
  v_cmp_ne_u32 vcc, 0, v14
  s_cbranch_vccz L_p1_done
  s_mov_b64 exec, vcc
  buffer_load_dwordx4 v[200:203], v20, s[48:51], s69 offen offset:1024 sc1
  buffer_load_dwordx4 v[204:207], v19, s[48:51], s74 offen sc1
  s_waitcnt vmcnt(2)
  v_xor_b32 v232, s78, v212
  v_xor_b32 v233, s78, v213
  v_xor_b32 v234, s78, v214
  v_xor_b32 v235, s78, v215
  v_xor_b32 v17, s79, v209
  v_xor_b32 v18, s79, v211
  v_or3_b32 v14, v232, v233, v234
  v_or_b32 v14, v14, v235
  v_mov_b32 v15, v208
  v_and_b32 v14, 0xff, v14
  v_or3_b32 v14, v14, v17, v18
  v_mov_b32 v16, v210
  v_cmp_ne_u32 vcc, 0, v14
  s_cbranch_vccz L_p1_done
  s_mov_b64 exec, vcc
  s_sub_u32 s70, s70, 1
  s_cmp_lg_u32 s70, 0
  s_cbranch_scc1 L_p1
L_p1_done:
  s_mov_b64 exec, -1
  v_max_f32_dpp v17, v15, v15 quad_perm:[1,0,3,2] row_mask:0xf bank_mask:0xf
  s_nop 1
  v_max_f32_dpp v17, v17, v17 quad_perm:[2,3,0,1] row_mask:0xf bank_mask:0xf
  s_nop 1
  v_max_f32_dpp v17, v17, v17 row_half_mirror row_mask:0xf bank_mask:0xf
  v_sub_f32 v15, v15, v17
  v_exp_f32 v15, v15
  s_nop 0
  v_mul_f32 v16, v15, v16
  v_mul_f32 v232, v15, v232
  v_mul_f32 v233, v15, v233
  v_mul_f32 v234, v15, v234
  v_mul_f32 v235, v15, v235
  v_add_f32_dpp v16, v16, v16 quad_perm:[1,0,3,2] row_mask:0xf bank_mask:0xf
  v_add_f32_dpp v232, v232, v232 quad_perm:[1,0,3,2] row_mask:0xf bank_mask:0xf
  v_add_f32_dpp v233, v233, v233 quad_perm:[1,0,3,2] row_mask:0xf bank_mask:0xf
  v_add_f32_dpp v234, v234, v234 quad_perm:[1,0,3,2] row_mask:0xf bank_mask:0xf
  v_add_f32_dpp v235, v235, v235 quad_perm:[1,0,3,2] row_mask:0xf bank_mask:0xf
  v_add_f32_dpp v16, v16, v16 quad_perm:[2,3,0,1] row_mask:0xf bank_mask:0xf
  v_add_f32_dpp v232, v232, v232 quad_perm:[2,3,0,1] row_mask:0xf bank_mask:0xf
  v_add_f32_dpp v233, v233, v233 quad_perm:[2,3,0,1] row_mask:0xf bank_mask:0xf
  v_add_f32_dpp v234, v234, v234 quad_perm:[2,3,0,1] row_mask:0xf bank_mask:0xf
  v_add_f32_dpp v235, v235, v235 quad_perm:[2,3,0,1] row_mask:0xf bank_mask:0xf
  v_add_f32_dpp v16, v16, v16 row_half_mirror row_mask:0xf bank_mask:0xf
  v_add_f32_dpp v232, v232, v232 row_half_mirror row_mask:0xf bank_mask:0xf
  v_add_f32_dpp v233, v233, v233 row_half_mirror row_mask:0xf bank_mask:0xf
  v_add_f32_dpp v234, v234, v234 row_half_mirror row_mask:0xf bank_mask:0xf
  v_add_f32_dpp v235, v235, v235 row_half_mirror row_mask:0xf bank_mask:0xf
  v_rcp_f32 v16, v16
  s_nop 0
  v_mul_f32 v232, v232, v16
  v_mul_f32 v233, v233, v16
  v_mul_f32 v234, v234, v16
  v_mul_f32 v235, v235, v16
  v_cvt_pk_bf16_f32 v236, v232, v233
  v_cvt_pk_bf16_f32 v237, v234, v235
  ds_write_b64 v22, v[236:237] offset:1792
  ds_write_b32 v12, v29 offset:540
  s_branch L_proj
L_ow:
  ds_read_b32 v14, v12 offset:540
  ds_read_b64 v[236:237], v22 offset:1792
  s_waitcnt lgkmcnt(0)
  v_cmp_eq_u32 vcc, 0, v14
  s_cbranch_vccnz L_ow
L_proj:
  v_perm_b32 v48, v236, v236, v40
  v_perm_b32 v49, v236, v236, v41
  v_perm_b32 v50, v236, v236, v42
  v_perm_b32 v51, v236, v236, v43
  v_perm_b32 v52, v236, v236, v44
  v_perm_b32 v53, v236, v236, v45
  v_perm_b32 v54, v236, v236, v46
  v_perm_b32 v55, v236, v236, v47
  v_mfma_f32_16x16x32_bf16 v[240:243], v[104:107], v[48:51], 0
  v_mfma_f32_16x16x32_bf16 v[244:247], v[120:123], v[48:51], 0
  v_perm_b32 v56, v237, v237, v40
  v_perm_b32 v57, v237, v237, v41
  v_perm_b32 v58, v237, v237, v42
  v_perm_b32 v59, v237, v237, v43
  v_mfma_f32_16x16x32_bf16 v[240:243], v[108:111], v[52:55], v[240:243]
  v_mfma_f32_16x16x32_bf16 v[244:247], v[124:127], v[52:55], v[244:247]
  v_perm_b32 v60, v237, v237, v44
  v_perm_b32 v61, v237, v237, v45
  v_perm_b32 v62, v237, v237, v46
  v_perm_b32 v63, v237, v237, v47
  v_mfma_f32_16x16x32_bf16 v[240:243], v[112:115], v[56:59], v[240:243]
  v_mfma_f32_16x16x32_bf16 v[244:247], v[128:131], v[56:59], v[244:247]
  v_mfma_f32_16x16x32_bf16 v[240:243], v[116:119], v[60:63], v[240:243]
  v_mfma_f32_16x16x32_bf16 v[244:247], v[132:135], v[60:63], v[244:247]
  s_cmp_lg_u32 s30, 3
  s_cbranch_scc1 L_nob8a
  v_mfma_f32_16x16x32_bf16 v[248:251], v[136:139], v[48:51], 0
  v_mfma_f32_16x16x32_bf16 v[248:251], v[140:143], v[52:55], v[248:251]
  v_mfma_f32_16x16x32_bf16 v[248:251], v[144:147], v[56:59], v[248:251]
  v_mfma_f32_16x16x32_bf16 v[248:251], v[148:151], v[60:63], v[248:251]
L_nob8a:
  s_nop 5
  v_permlane32_swap_b32 v240, v244
  v_permlane32_swap_b32 v241, v245
  v_permlane32_swap_b32 v242, v246
  v_permlane32_swap_b32 v243, v247
  s_nop 0
  v_add_f32_dpp v240, v244, v240 row_ror:8 row_mask:0xf bank_mask:0xf
  v_add_f32_dpp v241, v245, v241 row_ror:8 row_mask:0xf bank_mask:0xf
  v_add_f32_dpp v242, v246, v242 row_ror:8 row_mask:0xf bank_mask:0xf
  v_add_f32_dpp v243, v247, v243 row_ror:8 row_mask:0xf bank_mask:0xf
  v_bfi_b32 v240, s75, v28, v240
  v_bfi_b32 v241, s75, v28, v241
  v_bfi_b32 v242, s75, v28, v242
  v_bfi_b32 v243, s75, v28, v243
  s_mov_b32 exec_lo, 0x00ff00ff
  s_mov_b32 exec_hi, 0x00ff00ff
  buffer_store_dwordx4 v[240:243], v21, s[48:51], s76 offen sc1
  s_mov_b64 exec, -1
  s_cmp_lg_u32 s30, 3
  s_cbranch_scc1 L_nob8b
  v_permlane32_swap_b32 v248, v244
  v_permlane32_swap_b32 v249, v245
  v_permlane32_swap_b32 v250, v246
  v_permlane32_swap_b32 v251, v247
  s_nop 0
  v_add_f32_dpp v248, v244, v248 row_ror:8 row_mask:0xf bank_mask:0xf
  v_add_f32_dpp v249, v245, v249 row_ror:8 row_mask:0xf bank_mask:0xf
  v_add_f32_dpp v250, v246, v250 row_ror:8 row_mask:0xf bank_mask:0xf
  v_add_f32_dpp v251, v247, v251 row_ror:8 row_mask:0xf bank_mask:0xf
  v_bfi_b32 v248, s75, v28, v248
  v_bfi_b32 v249, s75, v28, v249
  v_bfi_b32 v250, s75, v28, v250
  v_bfi_b32 v251, s75, v28, v251
  s_mov_b64 exec, 0x00ff00ff
  buffer_store_dwordx4 v[248:251], v21, s[48:51], s77 offen offset:2048 sc1
  s_mov_b64 exec, -1
L_nob8b:
  s_cmp_lg_u32 s3, 2
  s_cbranch_scc1 L_hend
  s_mov_b32 s70, s80
  s_mov_b64 s[60:61], -1
  s_mov_b64 s[62:63], -1
  s_mov_b64 s[64:65], -1
  s_mov_b64 s[66:67], -1
  buffer_load_dwordx4 v[64:67], v31, s[48:51], s81 offen sc1
  buffer_load_dwordx4 v[68:71], v31, s[48:51], s82 offen sc1
  buffer_load_dwordx4 v[72:75], v31, s[48:51], s46 offen sc1
  buffer_load_dwordx4 v[76:79], v31, s[48:51], s47 offen sc1
  s_sleep 6
L_ga:
  s_or_b64 exec, s[60:61], 1
  buffer_load_dwordx4 v[80:83], v31, s[48:51], s81 offen sc1
  s_or_b64 exec, s[62:63], 1
  buffer_load_dwordx4 v[84:87], v31, s[48:51], s82 offen sc1
  s_or_b64 exec, s[64:65], 1
  buffer_load_dwordx4 v[88:91], v31, s[48:51], s46 offen sc1
  s_or_b64 exec, s[66:67], 1
  buffer_load_dwordx4 v[92:95], v31, s[48:51], s47 offen sc1
  s_waitcnt vmcnt(4)
  s_mov_b64 exec, s[60:61]
  s_cbranch_execz L_gc0_0
  v_xor_b32 v176, s78, v64
  v_xor_b32 v177, s78, v65
  v_xor_b32 v178, s78, v66
  v_xor_b32 v179, s78, v67
  v_or3_b32 v17, v176, v177, v178
  v_or_b32 v17, v17, v179
  v_and_b32 v17, 0xff, v17
  v_cmp_ne_u32 s[60:61], 0, v17
L_gc0_0:
  s_mov_b64 exec, s[62:63]
  s_cbranch_execz L_gc0_1
  v_xor_b32 v180, s78, v68
  v_xor_b32 v181, s78, v69
  v_xor_b32 v182, s78, v70
  v_xor_b32 v183, s78, v71
  v_or3_b32 v17, v180, v181, v182
  v_or_b32 v17, v17, v183
  v_and_b32 v17, 0xff, v17
  v_cmp_ne_u32 s[62:63], 0, v17
L_gc0_1:
  s_mov_b64 exec, s[64:65]
  s_cbranch_execz L_gc0_2
  v_xor_b32 v184, s78, v72
  v_xor_b32 v185, s78, v73
  v_xor_b32 v186, s78, v74
  v_xor_b32 v187, s78, v75
  v_or3_b32 v17, v184, v185, v186
  v_or_b32 v17, v17, v187
  v_and_b32 v17, 0xff, v17
  v_cmp_ne_u32 s[64:65], 0, v17
L_gc0_2:
  s_mov_b64 exec, s[66:67]
  s_cbranch_execz L_gc0_3
  v_xor_b32 v188, s78, v76
  v_xor_b32 v189, s78, v77
  v_xor_b32 v190, s78, v78
  v_xor_b32 v191, s78, v79
  v_or3_b32 v17, v188, v189, v190
  v_or_b32 v17, v17, v191
  v_and_b32 v17, 0xff, v17
  v_cmp_ne_u32 s[66:67], 0, v17
L_gc0_3:
  s_or_b64 s[38:39], s[60:61], s[62:63]
  s_or_b64 s[38:39], s[38:39], s[64:65]
  s_or_b64 s[38:39], s[38:39], s[66:67]
  s_cbranch_scc0 L_ga_done
  s_or_b64 exec, s[60:61], 1
  buffer_load_dwordx4 v[64:67], v31, s[48:51], s81 offen sc1
  s_or_b64 exec, s[62:63], 1
  buffer_load_dwordx4 v[68:71], v31, s[48:51], s82 offen sc1
  s_or_b64 exec, s[64:65], 1
  buffer_load_dwordx4 v[72:75], v31, s[48:51], s46 offen sc1
  s_or_b64 exec, s[66:67], 1
  buffer_load_dwordx4 v[76:79], v31, s[48:51], s47 offen sc1
  s_waitcnt vmcnt(4)
  s_mov_b64 exec, s[60:61]
  s_cbranch_execz L_gc1_0
  v_xor_b32 v176, s78, v80
  v_xor_b32 v177, s78, v81
  v_xor_b32 v178, s78, v82
  v_xor_b32 v179, s78, v83
  v_or3_b32 v17, v176, v177, v178
  v_or_b32 v17, v17, v179
  v_and_b32 v17, 0xff, v17
  v_cmp_ne_u32 s[60:61], 0, v17
L_gc1_0:
  s_mov_b64 exec, s[62:63]
  s_cbranch_execz L_gc1_1
  v_xor_b32 v180, s78, v84
  v_xor_b32 v181, s78, v85
  v_xor_b32 v182, s78, v86
  v_xor_b32 v183, s78, v87
  v_or3_b32 v17, v180, v181, v182
  v_or_b32 v17, v17, v183
  v_and_b32 v17, 0xff, v17
  v_cmp_ne_u32 s[62:63], 0, v17
L_gc1_1:
  s_mov_b64 exec, s[64:65]
  s_cbranch_execz L_gc1_2
  v_xor_b32 v184, s78, v88
  v_xor_b32 v185, s78, v89
  v_xor_b32 v186, s78, v90
  v_xor_b32 v187, s78, v91
  v_or3_b32 v17, v184, v185, v186
  v_or_b32 v17, v17, v187
  v_and_b32 v17, 0xff, v17
  v_cmp_ne_u32 s[64:65], 0, v17
L_gc1_2:
  s_mov_b64 exec, s[66:67]
  s_cbranch_execz L_gc1_3
  v_xor_b32 v188, s78, v92
  v_xor_b32 v189, s78, v93
  v_xor_b32 v190, s78, v94
  v_xor_b32 v191, s78, v95
  v_or3_b32 v17, v188, v189, v190
  v_or_b32 v17, v17, v191
  v_and_b32 v17, 0xff, v17
  v_cmp_ne_u32 s[66:67], 0, v17
L_gc1_3:
  s_or_b64 s[38:39], s[60:61], s[62:63]
  s_or_b64 s[38:39], s[38:39], s[64:65]
  s_or_b64 s[38:39], s[38:39], s[66:67]
  s_cbranch_scc0 L_ga_done
  s_sub_u32 s70, s70, 1
  s_cmp_lg_u32 s70, 0
  s_cbranch_scc1 L_ga
L_ga_done:
  s_mov_b64 exec, -1
  v_add_f32 v176, v176, v180
  v_add_f32 v184, v184, v188
  v_add_f32 v177, v177, v181
  v_add_f32 v185, v185, v189
  v_add_f32 v178, v178, v182
  v_add_f32 v186, v186, v190
  v_add_f32 v179, v179, v183
  v_add_f32 v187, v187, v191
  v_add_f32 v176, v176, v184
  v_add_f32 v177, v177, v185
  v_add_f32 v178, v178, v186
  v_add_f32 v179, v179, v187
  s_lshl_b32 s64, s30, 8
  v_permlane32_swap_b32 v176, v177
  v_permlane32_swap_b32 v178, v179
  v_add_f32 v176, v176, v177
  v_add_f32 v178, v178, v179
  v_add_u32 v17, s64, v23
  s_nop 0
  v_permlane16_swap_b32 v176, v178
  v_add_f32 v176, v176, v178
  s_nop 1
  v_add_f32_dpp v176, v176, v176 row_ror:8 row_mask:0xf bank_mask:0xf
  ds_write_b32 v17, v176 offset:2304
  s_mov_b64 exec, 1
  ds_add_rtn_u32 v14, v12, v29 offset:544
  s_mov_b64 exec, -1
  ds_read_b32 v180, v23 offset:2304
  ds_read_b32 v181, v23 offset:2560
  ds_read_b32 v182, v23 offset:2816
  ds_read_b32 v183, v23 offset:3072
  s_waitcnt lgkmcnt(0)
  v_readfirstlane_b32 s64, v14
  v_add_f32 v176, v180, v181
  v_add_f32 v177, v182, v183
  s_cmp_lg_u32 s64, 3
  s_cbranch_scc1 L_hend
  v_add_f32 v176, v176, v177
  v_cvt_pk_bf16_f32 v176, 0, v176
  v_add_f32 v176, v26, v176
  v_cvt_pk_bf16_f32 v176, 0, v176
  v_add_f32 v176, v176, v27
  v_cvt_pk_bf16_f32 v176, v176, v176
  s_mov_b32 exec_lo, 0x00ff00ff
  s_mov_b32 exec_hi, 0x00ff00ff
  buffer_store_short v176, v25, s[56:59], 0 offen
  s_cmp_lg_u32 s73, 0
  s_cbranch_scc1 L_noep
  v_mov_b32 v17, s79
  s_lshl_b32 s64, s33, 2
  s_add_u32 s64, s64, 974848
  s_mov_b64 exec, 1
  buffer_store_dword v17, v12, s[48:51], s64 offen
L_noep:
  s_mov_b64 exec, -1
L_hend:
L_end:
  s_endpgm
.section .rodata,"a"
.p2align 6
.amdhsa_kernel parallel_sum__gqa_block_cached__mixer_token_mlp__decode_kernel
  .amdhsa_next_free_vgpr 256
  .amdhsa_next_free_sgpr 102
  .amdhsa_accum_offset 256
  .amdhsa_group_segment_fixed_size 0
  .amdhsa_kernarg_size 104
  .amdhsa_user_sgpr_count 2
  .amdhsa_user_sgpr_kernarg_segment_ptr 1
  .amdhsa_system_sgpr_workgroup_id_x 1
.end_amdhsa_kernel
```
